```python
import torch

def _softmax(x, axis=-1):
    return torch.softmax(x, dim=axis)

def _gelu(x):
    return torch.nn.functional.gelu(x, approximate='tanh')

def _silu(x):
    return torch.nn.functional.silu(x)

def _sigmoid(x):
    return torch.sigmoid(x)

def _layernorm(x, axis=-1, eps=1e-05):
    m = x.mean(dim=axis, keepdim=True)
    v = x.var(dim=axis, keepdim=True, unbiased=False)
    return (x - m) / torch.sqrt(v + eps)

def _scatter_add(tgt, idx, src, axis=0):
    return tgt.clone().index_add_(axis, idx, src)

def _segment_sum(src, seg, n):
    out = torch.zeros((n,) + src.shape[1:], dtype=src.dtype)
    return out.index_add_(0, seg, src)

def _pad(x, pw):
    flat = tuple((v for pair in reversed(pw) for v in pair))
    return torch.nn.functional.pad(x, flat)
kernel_name = 'standalone__kv_cache_quant_pre_rope_vs_post_rope__prompt'

def setup_inputs():

    _w = lambda a: (lambda t: t.to(torch.bfloat16) if t.is_floating_point() else t)(torch.as_tensor(a))
    B, Sq, Skv = (1, 2048, 2048)
    H, Dh0 = (4, 128)
    G = 64 if 64 > 0 else Dh0
    G = max(2, G // 2 * 2)
    Dh = max(G, Dh0 // G * G)
    Skv = max(Skv, Sq)
    ng = Dh // G
    bits = 8 if 8 > 1 else 4
    bits = max(2, min(8, bits))
    qmax = (1 << bits) - 1
    half = Dh // 2
    inv = 1.0 / 10000.0 ** (torch.arange(half) / max(1, half))
    ang_k = torch.arange(Skv)[:, None] * inv[None, :]
    ang_q = torch.arange(Skv - Sq, Skv)[:, None] * inv[None, :]
    kc = torch.cat([torch.cos(ang_k), torch.cos(ang_k)], dim=-1)
    ks = torch.cat([torch.sin(ang_k), torch.sin(ang_k)], dim=-1)
    qc = torch.cat([torch.cos(ang_q), torch.cos(ang_q)], dim=-1)
    qs = torch.cat([torch.sin(ang_q), torch.sin(ang_q)], dim=-1)
    qk_i = torch.randint(0, qmax + 1, (B, H, Skv, Dh)).to(torch.int32)
    qv_i = torch.randint(0, qmax + 1, (B, H, Skv, Dh)).to(torch.int32)
    ksc = torch.abs((lambda *s: torch.randn(*s, dtype=torch.bfloat16) * 0.05)(B, H, Skv, ng)) * 0.1 + 0.01
    kzp = torch.full((B, H, Skv, ng), qmax / 2.0)
    vsc = torch.abs((lambda *s: torch.randn(*s, dtype=torch.bfloat16) * 0.05)(B, H, Skv, ng)) * 0.1 + 0.01
    vzp = torch.full((B, H, Skv, ng), qmax / 2.0)
    return {'q': _w((lambda *s: torch.randn(*s, dtype=torch.bfloat16) * 0.8)(B, H, Sq, Dh) * 0.5), 'qk': _w(qk_i), 'k_scales': _w(ksc), 'k_zeros': _w(kzp), 'qv': _w(qv_i), 'v_scales': _w(vsc), 'v_zeros': _w(vzp), 'q_cos': _w(qc), 'q_sin': _w(qs), 'k_cos': _w(kc), 'k_sin': _w(ks)}

def reference(q, qk, k_scales, k_zeros, qv, v_scales, v_zeros, q_cos, q_sin, k_cos, k_sin):
    B, H, Sq, Dh = q.shape
    ng = k_scales.shape[-1]
    G = Dh // ng
    half = Dh // 2
    ks = (lambda x, n, axis: torch.repeat_interleave(x, n, dim=axis))(k_scales, G, axis=-1)
    kz = (lambda x, n, axis: torch.repeat_interleave(x, n, dim=axis))(k_zeros, G, axis=-1)
    k = ((lambda x, dt: x.to(dt))(qk, q.dtype) - kz) * ks
    vs = (lambda x, n, axis: torch.repeat_interleave(x, n, dim=axis))(v_scales, G, axis=-1)
    vz = (lambda x, n, axis: torch.repeat_interleave(x, n, dim=axis))(v_zeros, G, axis=-1)
    v = ((lambda x, dt: x.to(dt))(qv, q.dtype) - vz) * vs
    k1 = k[..., :half].clone()
    k2 = k[..., half:].clone()
    krh = torch.concatenate([-k2, k1], axis=-1)
    kr = k * k_cos[None, None, :, :] + krh * k_sin[None, None, :, :]
    q1 = q[..., :half].clone()
    q2 = q[..., half:].clone()
    qrh = torch.concatenate([-q2, q1], axis=-1)
    qr = q * q_cos[None, None, :, :] + qrh * q_sin[None, None, :, :]
    logits = torch.einsum('bhqd,bhkd->bhqk', qr, kr) * float(Dh) ** (-0.5)
    attn = _softmax(logits, axis=-1)
    out = torch.einsum('bhqk,bhkd->bhqd', attn, v)
    return out
```

```asm
; @launch grid=(256,1,1) block=(256,1,1) lds=94208
.amdgcn_target "amdgcn-amd-amdhsa--gfx950"
.text
.globl standalone__kv_cache_quant_pre_rope_vs_post_rope__prompt_kernel
.p2align 8
.type standalone__kv_cache_quant_pre_rope_vs_post_rope__prompt_kernel,@function
standalone__kv_cache_quant_pre_rope_vs_post_rope__prompt_kernel:
s_cmp_ge_u32 s2, 256
s_cbranch_scc1 Lend
s_load_dwordx16 s[4:19], s[0:1], 0
s_load_dwordx2 s[22:23], s[0:1], 104
s_load_dwordx2 s[20:21], s[0:1], 88
s_getpc_b64 s[30:31]
Lpc:
s_lshr_b32 s28, s2, 3
v_and_b32 v1, 15, v0
v_lshl_add_u32 v1, s28, 4, v1
v_lshlrev_b32 v1, 6, v1
v_min_u32 v1, Lcode_end-Lpc-4, v1
global_load_dword v255, v1, s[30:31]
v_lshrrev_b32 v193, 3, v0
v_lshrrev_b32 v1, 6, v0
v_and_b32 v0, 63, v0
v_readfirstlane_b32 s3, v1
s_and_b32 s30, s2, 7
s_lshl_b32 s25, s30, 5
s_add_u32 s25, s25, s28
s_lshr_b32 s44, s30, 1
s_lshl_b32 s44, s44, 7
s_add_u32 s44, s44, 7340032
s_lshl_b32 s45, s25, 5
v_and_b32 v194, 7, v0
v_add_u32 v195, s45, v193
v_lshlrev_b32 v198, 8, v195
v_lshl_add_u32 v198, v194, 4, v198
v_lshlrev_b32 v196, 1, v198
v_lshlrev_b32 v197, 2, v195
v_xor_b32 v199, 8192, v198
v_lshrrev_b32 v200, 3, v0
v_lshl_add_u32 v200, v200, 2, s45
v_lshlrev_b32 v201, 4, v194
v_lshl_add_u32 v201, v1, 7, v201
v_lshl_add_u32 v201, v200, 9, v201
v_lshlrev_b32 v200, 2, v200
v_lshlrev_b32 v205, 3, v194
v_cvt_f32_u32 v205, v205
s_mov_b32 s45, 0xbe549a78
v_add_f32 v148, 0.0, v205
v_add_f32 v149, 1.0, v205
v_add_f32 v150, 2.0, v205
v_add_f32 v151, 0x40400000, v205
v_add_f32 v152, 4.0, v205
v_add_f32 v153, 0x40a00000, v205
v_add_f32 v154, 0x40c00000, v205
v_add_f32 v155, 0x40e00000, v205
v_mul_f32 v148, s45, v148
v_mul_f32 v149, s45, v149
v_mul_f32 v150, s45, v150
v_mul_f32 v151, s45, v151
v_mul_f32 v152, s45, v152
v_mul_f32 v153, s45, v153
v_mul_f32 v154, s45, v154
v_mul_f32 v155, s45, v155
v_exp_f32 v148, v148
v_exp_f32 v149, v149
v_exp_f32 v150, v150
v_exp_f32 v151, v151
v_exp_f32 v152, v152
v_exp_f32 v153, v153
v_exp_f32 v154, v154
v_exp_f32 v155, v155
v_and_b32 v205, 2047, v195
v_xor_b32 v206, 32, v205
v_cvt_f32_u32 v205, v205
v_cvt_f32_u32 v206, v206
v_mul_f32 v148, 0.15915494, v148
v_mul_f32 v149, 0.15915494, v149
v_mul_f32 v150, 0.15915494, v150
v_mul_f32 v151, 0.15915494, v151
v_mul_f32 v152, 0.15915494, v152
v_mul_f32 v153, 0.15915494, v153
v_mul_f32 v154, 0.15915494, v154
v_mul_f32 v155, 0.15915494, v155
s_mov_b32 s31, 0xffff0000
v_mul_f32 v156, v205, v148
v_mul_f32 v157, v205, v149
v_mul_f32 v158, v205, v150
v_mul_f32 v159, v205, v151
v_mul_f32 v160, v205, v152
v_mul_f32 v161, v205, v153
v_mul_f32 v162, v205, v154
v_mul_f32 v163, v205, v155
v_fract_f32 v156, v156
v_fract_f32 v157, v157
v_fract_f32 v158, v158
v_fract_f32 v159, v159
v_fract_f32 v160, v160
v_fract_f32 v161, v161
v_fract_f32 v162, v162
v_fract_f32 v163, v163
v_cos_f32 v116, v156
v_sin_f32 v124, v156
v_cos_f32 v117, v157
v_sin_f32 v125, v157
v_cos_f32 v118, v158
v_sin_f32 v126, v158
v_cos_f32 v119, v159
v_sin_f32 v127, v159
v_cos_f32 v120, v160
v_sin_f32 v128, v160
v_cos_f32 v121, v161
v_sin_f32 v129, v161
v_cos_f32 v122, v162
v_sin_f32 v130, v162
v_cos_f32 v123, v163
v_sin_f32 v131, v163
s_nop 0
v_cvt_pk_bf16_f32 v156, v116, v117
v_cvt_pk_bf16_f32 v157, v118, v119
v_cvt_pk_bf16_f32 v158, v120, v121
v_cvt_pk_bf16_f32 v159, v122, v123
v_cvt_pk_bf16_f32 v160, v124, v125
v_cvt_pk_bf16_f32 v161, v126, v127
v_cvt_pk_bf16_f32 v162, v128, v129
v_cvt_pk_bf16_f32 v163, v130, v131
v_lshlrev_b32 v116, 16, v156
v_and_b32 v117, s31, v156
v_lshlrev_b32 v118, 16, v157
v_and_b32 v119, s31, v157
v_lshlrev_b32 v120, 16, v158
v_and_b32 v121, s31, v158
v_lshlrev_b32 v122, 16, v159
v_and_b32 v123, s31, v159
v_lshlrev_b32 v124, 16, v160
v_and_b32 v125, s31, v160
v_lshlrev_b32 v126, 16, v161
v_and_b32 v127, s31, v161
v_lshlrev_b32 v128, 16, v162
v_and_b32 v129, s31, v162
v_lshlrev_b32 v130, 16, v163
v_and_b32 v131, s31, v163
s_waitcnt lgkmcnt(0)
s_load_dword s24, s[22:23], s44
s_lshl_b32 s45, s25, 13
global_load_dwordx4 v[16:19], v196, s[6:7] offset:0
global_load_dwordx4 v[20:23], v196, s[6:7] offset:16
global_load_dwordx4 v[24:27], v196, s[6:7] offset:256
global_load_dwordx4 v[28:31], v196, s[6:7] offset:272
global_load_dword v32, v197, s[8:9]
global_load_dword v33, v197, s[10:11]
s_lshl_b32 s48, s45, 1
s_cmp_eq_u32 s3, 1
s_cselect_b32 s46, s20, s12
s_cselect_b32 s47, s21, s13
s_cselect_b32 s48, s45, s48
v_mov_b32 v208, s48
global_load_dword v255, v208, s[46:47] sc1
s_mov_b64 s[60:61], s[12:13]
s_and_b32 s29, s28, 1
s_cmp_lg_u32 s3, 0
s_cbranch_scc1 Lnopre
s_lshl_b32 s46, s30, 1
s_add_u32 s46, s46, s29
s_lshl_b32 s46, s46, 7
s_add_u32 s46, s46, 7344128
s_lshr_b32 s47, s25, 4
s_lshl_b32 s47, s47, 7
s_add_u32 s47, s47, 7393280
s_xor_b32 s48, s25, 1
s_lshl_b32 s48, s48, 10
s_add_u32 s48, s48, 5242880
v_cmp_lt_u32 vcc, 31, v0
v_lshl_add_u32 v14, v0, 11, s46
v_min_u32 v14, s47, v14
v_lshl_add_u32 v204, v194, 7, s48
v_cndmask_b32 v14, v14, v204, vcc
global_load_dword v254, v14, s[22:23] sc1
Lnopre:
v_and_b32 v207, 15, v193
v_lshlrev_b32 v207, 4, v207
v_lshl_add_u32 v207, v194, 8, v207
s_lshl_b32 s45, s25, 14
s_lshr_b32 s46, s3, 1
s_lshl_b32 s47, s46, 12
s_add_u32 s45, s45, s47
s_add_u32 s45, s45, 0
s_and_b32 s47, s25, 1
s_lshl_b32 s47, s47, 13
s_add_u32 s45, s45, s47
v_add_u32 v196, s45, v207
v_mul_f32 v156, v206, v148
v_mul_f32 v157, v206, v149
v_mul_f32 v158, v206, v150
v_mul_f32 v159, v206, v151
v_mul_f32 v160, v206, v152
v_mul_f32 v161, v206, v153
v_mul_f32 v162, v206, v154
v_mul_f32 v163, v206, v155
v_fract_f32 v156, v156
v_fract_f32 v157, v157
v_fract_f32 v158, v158
v_fract_f32 v159, v159
v_fract_f32 v160, v160
v_fract_f32 v161, v161
v_fract_f32 v162, v162
v_fract_f32 v163, v163
v_cos_f32 v132, v156
v_sin_f32 v140, v156
v_cos_f32 v133, v157
v_sin_f32 v141, v157
v_cos_f32 v134, v158
v_sin_f32 v142, v158
v_cos_f32 v135, v159
v_sin_f32 v143, v159
v_cos_f32 v136, v160
v_sin_f32 v144, v160
v_cos_f32 v137, v161
v_sin_f32 v145, v161
v_cos_f32 v138, v162
v_sin_f32 v146, v162
v_cos_f32 v139, v163
v_sin_f32 v147, v163
s_nop 0
v_cvt_pk_bf16_f32 v156, v132, v133
v_cvt_pk_bf16_f32 v157, v134, v135
v_cvt_pk_bf16_f32 v158, v136, v137
v_cvt_pk_bf16_f32 v159, v138, v139
v_cvt_pk_bf16_f32 v160, v140, v141
v_cvt_pk_bf16_f32 v161, v142, v143
v_cvt_pk_bf16_f32 v162, v144, v145
v_cvt_pk_bf16_f32 v163, v146, v147
v_lshlrev_b32 v132, 16, v156
v_and_b32 v133, s31, v156
v_lshlrev_b32 v134, 16, v157
v_and_b32 v135, s31, v157
v_lshlrev_b32 v136, 16, v158
v_and_b32 v137, s31, v158
v_lshlrev_b32 v138, 16, v159
v_and_b32 v139, s31, v159
v_lshlrev_b32 v140, 16, v160
v_and_b32 v141, s31, v160
v_lshlrev_b32 v142, 16, v161
v_and_b32 v143, s31, v161
v_lshlrev_b32 v144, 16, v162
v_and_b32 v145, s31, v162
v_lshlrev_b32 v146, 16, v163
v_and_b32 v147, s31, v163
s_waitcnt lgkmcnt(0)
global_load_dwordx4 v[100:103], v198, s[4:5] offset:0
global_load_dwordx4 v[104:107], v198, s[4:5] offset:128
global_load_dwordx4 v[108:111], v199, s[4:5] offset:0
global_load_dwordx4 v[112:115], v199, s[4:5] offset:128
global_load_dwordx4 v[52:55], v200, s[14:15]
global_load_dwordx4 v[56:59], v200, s[16:17]
s_mul_i32 s24, s24, 0x9e3779b1
s_add_u32 s24, s24, 0x7f4a7c18
s_getreg_b32 s26, hwreg(HW_REG_XCC_ID, 0, 3)
s_mov_b32 s8, s22
s_and_b32 s9, s23, 0xffff
s_mov_b32 s10, 16777216
s_mov_b32 s11, 0x20000
s_mov_b32 s12, s20
s_and_b32 s13, s21, 0xffff
s_mov_b32 s14, 2097152
s_mov_b32 s15, 0x20000
v_lshlrev_b32 v11, 4, v0
s_lshl_b32 s46, s29, 4
s_lshl_b32 s47, s30, 5
s_add_u32 s46, s46, s47
s_lshl_b32 s48, s46, 14
s_add_u32 s48, s48, 0
s_lshr_b32 s27, s28, 1
s_and_b32 s27, s27, 3
s_add_u32 s49, s27, 0
s_and_b32 s49, s49, 3
s_lshl_b32 s49, s49, 16
s_add_u32 s32, s48, s49
s_xor_b32 s49, s32, 0x80000
s_add_u32 s16, s22, s32
s_addc_u32 s17, s23, 0
s_add_u32 s36, s22, s49
s_addc_u32 s37, s23, 0
s_add_u32 s49, s27, 1
s_and_b32 s49, s49, 3
s_lshl_b32 s49, s49, 16
s_add_u32 s32, s48, s49
s_xor_b32 s49, s32, 0x80000
s_add_u32 s18, s22, s32
s_addc_u32 s19, s23, 0
s_add_u32 s38, s22, s49
s_addc_u32 s39, s23, 0
s_add_u32 s49, s27, 2
s_and_b32 s49, s49, 3
s_lshl_b32 s49, s49, 16
s_add_u32 s32, s48, s49
s_xor_b32 s49, s32, 0x80000
s_add_u32 s20, s22, s32
s_addc_u32 s21, s23, 0
s_add_u32 s40, s22, s49
s_addc_u32 s41, s23, 0
s_add_u32 s49, s27, 3
s_and_b32 s49, s49, 3
s_lshl_b32 s49, s49, 16
s_add_u32 s32, s48, s49
s_xor_b32 s49, s32, 0x80000
s_add_u32 s34, s22, s32
s_addc_u32 s35, s23, 0
s_add_u32 s42, s22, s49
s_addc_u32 s43, s23, 0
s_lshl_b32 s50, s46, 7
s_add_u32 s50, s50, 7405568
s_xor_b32 s51, s50, 4096
s_lshl_b32 s52, s46, 3
s_add_u32 s53, s52, 7344128
s_lshl_b32 s6, s46, 7
s_add_u32 s6, s6, 7471104
s_xor_b32 s7, s6, 4096
s_lshl_b32 s49, s3, 7
s_add_u32 s50, s50, s49
s_add_u32 s51, s51, s49
s_lshl_b32 s27, s27, 4
s_add_u32 s27, s27, s53
s_add_u32 s58, s22, s27
s_addc_u32 s59, s23, 0
s_lshl_b32 s48, s3, 4
s_add_u32 s52, s52, s48
s_add_u32 s52, s52, 7360512
s_add_u32 s62, s22, s52
s_addc_u32 s63, s23, 0
s_lshr_b32 s46, s25, 4
s_lshl_b32 s46, s46, 7
s_and_b32 s47, s25, 15
s_lshl_b32 s47, s47, 2
s_add_u32 s47, s47, s46
s_and_b32 s48, s25, 3
s_lshl_b32 s48, s48, 4
s_and_b32 s49, s25, 12
s_add_u32 s48, s48, s49
s_add_u32 s48, s48, s46
s_lshl_b32 s49, s3, 13
s_add_u32 s48, s48, s49
s_add_u32 s48, s48, 7360512
s_lshl_b32 s49, s3, 12
s_add_u32 s54, s47, s49
s_add_u32 s54, s54, 7344128
s_add_u32 s47, s47, 7393280
s_xor_b32 s27, s47, 4
s_add_u32 s46, s24, s26
v_mov_b32 v251, s24
v_mov_b32 v250, s46
v_cmp_lt_u32 vcc, 31, v0
v_and_b32 v252, 3, v0
v_lshl_add_u32 v252, v252, 11, s48
v_mov_b32 v249, s47
v_cndmask_b32 v250, v251, v250, vcc
v_cndmask_b32 v252, v252, v249, vcc
v_cndmask_b32 v253, 0, 8, vcc
v_and_b32 v249, 15, v0
v_lshl_add_u32 v248, v249, 2, s53
v_mov_b32 v247, s27
v_cndmask_b32 v248, v248, v247, vcc
v_and_b32 v249, 12, v0
v_lshlrev_b32 v249, 7, v249
v_and_b32 v244, 3, v0
v_lshl_add_u32 v244, v244, 2, v249
v_and_b32 v12, 1, v0
v_lshlrev_b32 v12, 11, v12
v_mov_b32 v13, 0
v_lshrrev_b32 v247, 5, v0
v_lshlrev_b32 v247, 7, v247
v_and_b32 v246, 15, v0
v_lshl_add_u32 v247, v246, 3, v247
s_lshl_b32 s55, s25, 7
s_add_u32 s55, s55, 7405568
s_xor_b32 s56, s55, 128
s_lshl_b32 s46, s3, 2
v_add_u32 v10, s46, v11
s_lshl_b32 s46, s25, 2
s_add_u32 s46, s46, s3
s_xor_b32 s47, s46, 4
s_lshl_b32 s33, s46, 8
s_add_u32 s33, s33, 5242880
s_lshl_b32 s52, s47, 8
s_add_u32 s52, s52, 5242880
s_lshl_b32 s57, s25, 13
s_lshl_b32 s46, s3, 6
s_add_u32 s57, s57, s46
s_lshl_b32 s46, s3, 14
s_add_u32 s46, s46, 4096
s_and_b32 s47, s3, 1
s_lshl_b32 s47, s47, 13
s_add_u32 s46, s46, s47
v_add_u32 v1, s46, v11
s_lshl_b32 s47, s3, 11
s_add_u32 s47, s47, 8192
s_add_u32 s48, s3, 0
s_and_b32 s48, s48, 3
s_lshl_b32 s49, s48, 14
s_add_u32 s49, s49, s47
s_and_b32 s45, s48, 1
s_lshl_b32 s45, s45, 13
s_xor_b32 s49, s49, s45
v_add_u32 v2, s49, v11
s_lshl_b32 s49, s48, 12
s_add_u32 s49, s49, 11264
v_add_u32 v6, s49, v11
s_add_u32 s48, s3, 1
s_and_b32 s48, s48, 3
s_lshl_b32 s49, s48, 14
s_add_u32 s49, s49, s47
s_and_b32 s45, s48, 1
s_lshl_b32 s45, s45, 13
s_xor_b32 s49, s49, s45
v_add_u32 v3, s49, v11
s_lshl_b32 s49, s48, 12
s_add_u32 s49, s49, 11264
v_add_u32 v7, s49, v11
s_add_u32 s48, s3, 2
s_and_b32 s48, s48, 3
s_lshl_b32 s49, s48, 14
s_add_u32 s49, s49, s47
s_and_b32 s45, s48, 1
s_lshl_b32 s45, s45, 13
s_xor_b32 s49, s49, s45
v_add_u32 v4, s49, v11
s_lshl_b32 s49, s48, 12
s_add_u32 s49, s49, 11264
v_add_u32 v8, s49, v11
s_add_u32 s48, s3, 3
s_and_b32 s48, s48, 3
s_lshl_b32 s49, s48, 14
s_add_u32 s49, s49, s47
s_and_b32 s45, s48, 1
s_lshl_b32 s45, s45, 13
s_xor_b32 s49, s49, s45
v_add_u32 v5, s49, v11
s_lshl_b32 s49, s48, 12
s_add_u32 s49, s49, 11264
v_add_u32 v9, s49, v11
v_and_b32 v15, 48, v0
v_add3_u32 v15, v15, v11, s49
s_sub_u32 s49, 76800, s49
v_add_u32 v15, s49, v15
s_lshl_b32 s45, s25, 14
s_add_u32 s47, s47, s45
s_add_u32 s47, s47, 0
s_and_b32 s45, s25, 1
s_lshl_b32 s45, s45, 13
s_xor_b32 s47, s47, s45
v_and_b32 v203, 31, v0
v_lshrrev_b32 v204, 5, v0
v_lshl_add_u32 v203, v203, 1, v204
v_lshl_add_u32 v203, v203, 4, s47
s_lshr_b32 s46, s3, 1
s_mul_i32 s47, s46, 4352
s_add_u32 s47, s47, 76800
v_lshl_add_u32 v197, v194, 4, v207
v_add_u32 v197, s47, v197
s_lshl_b32 s46, s46, 4
s_sub_u32 s46, 16, s46
v_mov_b32 v204, 0x3f803f80
v_accvgpr_write_b32 a112, v204
v_accvgpr_write_b32 a113, v204
v_accvgpr_write_b32 a114, v204
v_accvgpr_write_b32 a115, v204
s_and_b32 s30, s25, 0xfc
s_lshl_b32 s30, s30, 7
s_and_b32 s49, s25, 3
s_lshl_b32 s49, s49, 2
s_add_u32 s30, s30, s49
s_add_u32 s30, s30, 7471104
s_mov_b32 s25, s24
s_and_b32 s29, s28, 0
s_mov_b32 s28, s3
s_mov_b32 s45, 0x3e0293ee
s_waitcnt vmcnt(11)
v_cvt_f32_i32 v16, v16
v_cvt_f32_i32 v17, v17
v_cvt_f32_i32 v18, v18
v_cvt_f32_i32 v19, v19
v_cvt_f32_i32 v20, v20
v_cvt_f32_i32 v21, v21
v_cvt_f32_i32 v22, v22
v_cvt_f32_i32 v23, v23
s_waitcnt vmcnt(7)
v_lshlrev_b32 v172, 16, v32
v_and_b32 v174, s31, v32
v_lshlrev_b32 v173, 16, v33
v_and_b32 v175, s31, v33
v_mul_f32 v172, s45, v172
v_mul_f32 v174, s45, v174
v_mul_f32 v173, -v173, v172
v_mul_f32 v175, -v175, v174
v_cvt_f32_i32 v24, v24
v_cvt_f32_i32 v25, v25
v_cvt_f32_i32 v26, v26
v_cvt_f32_i32 v27, v27
v_cvt_f32_i32 v28, v28
v_cvt_f32_i32 v29, v29
v_cvt_f32_i32 v30, v30
v_cvt_f32_i32 v31, v31
v_pk_fma_f32 v[16:17], v[16:17], v[172:173], v[172:173] op_sel:[0,0,1] op_sel_hi:[1,0,1]
v_pk_fma_f32 v[18:19], v[18:19], v[172:173], v[172:173] op_sel:[0,0,1] op_sel_hi:[1,0,1]
v_pk_fma_f32 v[20:21], v[20:21], v[172:173], v[172:173] op_sel:[0,0,1] op_sel_hi:[1,0,1]
v_pk_fma_f32 v[22:23], v[22:23], v[172:173], v[172:173] op_sel:[0,0,1] op_sel_hi:[1,0,1]
v_pk_fma_f32 v[24:25], v[24:25], v[174:175], v[174:175] op_sel:[0,0,1] op_sel_hi:[1,0,1]
v_pk_fma_f32 v[26:27], v[26:27], v[174:175], v[174:175] op_sel:[0,0,1] op_sel_hi:[1,0,1]
v_pk_fma_f32 v[28:29], v[28:29], v[174:175], v[174:175] op_sel:[0,0,1] op_sel_hi:[1,0,1]
v_pk_fma_f32 v[30:31], v[30:31], v[174:175], v[174:175] op_sel:[0,0,1] op_sel_hi:[1,0,1]
v_pk_mul_f32 v[156:157], v[16:17], v[116:117]
v_pk_mul_f32 v[164:165], v[24:25], v[116:117]
v_pk_mul_f32 v[158:159], v[18:19], v[118:119]
v_pk_mul_f32 v[166:167], v[26:27], v[118:119]
v_pk_mul_f32 v[160:161], v[20:21], v[120:121]
v_pk_mul_f32 v[168:169], v[28:29], v[120:121]
v_pk_mul_f32 v[162:163], v[22:23], v[122:123]
v_pk_mul_f32 v[170:171], v[30:31], v[122:123]
v_pk_fma_f32 v[156:157], v[24:25], v[124:125], v[156:157] neg_lo:[1,0,0] neg_hi:[1,0,0]
v_pk_fma_f32 v[164:165], v[16:17], v[124:125], v[164:165]
v_pk_fma_f32 v[158:159], v[26:27], v[126:127], v[158:159] neg_lo:[1,0,0] neg_hi:[1,0,0]
v_pk_fma_f32 v[166:167], v[18:19], v[126:127], v[166:167]
v_pk_fma_f32 v[160:161], v[28:29], v[128:129], v[160:161] neg_lo:[1,0,0] neg_hi:[1,0,0]
v_pk_fma_f32 v[168:169], v[20:21], v[128:129], v[168:169]
v_pk_fma_f32 v[162:163], v[30:31], v[130:131], v[162:163] neg_lo:[1,0,0] neg_hi:[1,0,0]
v_pk_fma_f32 v[170:171], v[22:23], v[130:131], v[170:171]
v_cvt_pk_bf16_f32 v84, v156, v157
v_cvt_pk_bf16_f32 v85, v158, v159
v_cvt_pk_bf16_f32 v86, v160, v161
v_cvt_pk_bf16_f32 v87, v162, v163
v_cvt_pk_bf16_f32 v88, v164, v165
v_cvt_pk_bf16_f32 v89, v166, v167
v_cvt_pk_bf16_f32 v90, v168, v169
v_cvt_pk_bf16_f32 v91, v170, v171
global_store_dwordx4 v196, v[84:87], s[22:23] offset:0 sc1
global_store_dwordx4 v196, v[88:91], s[22:23] offset:2048 sc1
s_barrier
global_load_dwordx4 v[36:39], v201, s[60:61] offset:0
global_load_dwordx4 v[40:43], v201, s[60:61] offset:512
global_load_dwordx4 v[44:47], v201, s[60:61] offset:1024
global_load_dwordx4 v[48:51], v201, s[60:61] offset:1536
s_mov_b64 exec, 0
s_cmp_eq_u32 s3, 1
s_cbranch_scc1 Ltouch0
s_cmp_eq_u32 s3, 2
s_cbranch_scc1 Ltouch1
s_cmp_eq_u32 s3, 3
s_cbranch_scc1 Ltouch2
Lret:
s_mov_b64 exec, -1
s_waitcnt vmcnt(10)
v_lshlrev_b32 v16, 16, v100
v_and_b32 v17, s31, v100
v_lshlrev_b32 v18, 16, v101
v_and_b32 v19, s31, v101
v_lshlrev_b32 v20, 16, v102
v_and_b32 v21, s31, v102
v_lshlrev_b32 v22, 16, v103
v_and_b32 v23, s31, v103
v_lshlrev_b32 v24, 16, v104
v_and_b32 v25, s31, v104
v_lshlrev_b32 v26, 16, v105
v_and_b32 v27, s31, v105
v_lshlrev_b32 v28, 16, v106
v_and_b32 v29, s31, v106
v_lshlrev_b32 v30, 16, v107
v_and_b32 v31, s31, v107
v_pk_mul_f32 v[156:157], v[16:17], v[116:117]
v_pk_mul_f32 v[164:165], v[24:25], v[116:117]
v_pk_mul_f32 v[158:159], v[18:19], v[118:119]
v_pk_mul_f32 v[166:167], v[26:27], v[118:119]
v_pk_mul_f32 v[160:161], v[20:21], v[120:121]
v_pk_mul_f32 v[168:169], v[28:29], v[120:121]
v_pk_mul_f32 v[162:163], v[22:23], v[122:123]
v_pk_mul_f32 v[170:171], v[30:31], v[122:123]
v_pk_fma_f32 v[156:157], v[24:25], v[124:125], v[156:157] neg_lo:[1,0,0] neg_hi:[1,0,0]
v_pk_fma_f32 v[164:165], v[16:17], v[124:125], v[164:165]
v_pk_fma_f32 v[158:159], v[26:27], v[126:127], v[158:159] neg_lo:[1,0,0] neg_hi:[1,0,0]
v_pk_fma_f32 v[166:167], v[18:19], v[126:127], v[166:167]
v_pk_fma_f32 v[160:161], v[28:29], v[128:129], v[160:161] neg_lo:[1,0,0] neg_hi:[1,0,0]
v_pk_fma_f32 v[168:169], v[20:21], v[128:129], v[168:169]
v_pk_fma_f32 v[162:163], v[30:31], v[130:131], v[162:163] neg_lo:[1,0,0] neg_hi:[1,0,0]
v_pk_fma_f32 v[170:171], v[22:23], v[130:131], v[170:171]
v_cvt_pk_bf16_f32 v100, v156, v157
v_cvt_pk_bf16_f32 v101, v158, v159
v_cvt_pk_bf16_f32 v102, v160, v161
v_cvt_pk_bf16_f32 v103, v162, v163
v_cvt_pk_bf16_f32 v104, v164, v165
v_cvt_pk_bf16_f32 v105, v166, v167
v_cvt_pk_bf16_f32 v106, v168, v169
v_cvt_pk_bf16_f32 v107, v170, v171
ds_write_b128 v197, v[100:103] offset:8704
ds_write_b128 v197, v[104:107] offset:10880
s_waitcnt vmcnt(8)
v_lshlrev_b32 v16, 16, v108
v_and_b32 v17, s31, v108
v_lshlrev_b32 v18, 16, v109
v_and_b32 v19, s31, v109
v_lshlrev_b32 v20, 16, v110
v_and_b32 v21, s31, v110
v_lshlrev_b32 v22, 16, v111
v_and_b32 v23, s31, v111
v_lshlrev_b32 v24, 16, v112
v_and_b32 v25, s31, v112
v_lshlrev_b32 v26, 16, v113
v_and_b32 v27, s31, v113
v_lshlrev_b32 v28, 16, v114
v_and_b32 v29, s31, v114
v_lshlrev_b32 v30, 16, v115
v_and_b32 v31, s31, v115
v_pk_mul_f32 v[156:157], v[16:17], v[132:133]
v_pk_mul_f32 v[164:165], v[24:25], v[132:133]
v_pk_mul_f32 v[158:159], v[18:19], v[134:135]
v_pk_mul_f32 v[166:167], v[26:27], v[134:135]
v_pk_mul_f32 v[160:161], v[20:21], v[136:137]
v_pk_mul_f32 v[168:169], v[28:29], v[136:137]
v_pk_mul_f32 v[162:163], v[22:23], v[138:139]
v_pk_mul_f32 v[170:171], v[30:31], v[138:139]
v_pk_fma_f32 v[156:157], v[24:25], v[140:141], v[156:157] neg_lo:[1,0,0] neg_hi:[1,0,0]
v_pk_fma_f32 v[164:165], v[16:17], v[140:141], v[164:165]
v_pk_fma_f32 v[158:159], v[26:27], v[142:143], v[158:159] neg_lo:[1,0,0] neg_hi:[1,0,0]
v_pk_fma_f32 v[166:167], v[18:19], v[142:143], v[166:167]
v_pk_fma_f32 v[160:161], v[28:29], v[144:145], v[160:161] neg_lo:[1,0,0] neg_hi:[1,0,0]
v_pk_fma_f32 v[168:169], v[20:21], v[144:145], v[168:169]
v_pk_fma_f32 v[162:163], v[30:31], v[146:147], v[162:163] neg_lo:[1,0,0] neg_hi:[1,0,0]
v_pk_fma_f32 v[170:171], v[22:23], v[146:147], v[170:171]
v_cvt_pk_bf16_f32 v108, v156, v157
v_cvt_pk_bf16_f32 v109, v158, v159
v_cvt_pk_bf16_f32 v110, v160, v161
v_cvt_pk_bf16_f32 v111, v162, v163
v_cvt_pk_bf16_f32 v112, v164, v165
v_cvt_pk_bf16_f32 v113, v166, v167
v_cvt_pk_bf16_f32 v114, v168, v169
v_cvt_pk_bf16_f32 v115, v170, v171
ds_write_b128 v197, v[108:111] offset:0
ds_write_b128 v197, v[112:115] offset:2176
s_waitcnt vmcnt(6)
v_lshlrev_b32 v68, s46, v52
v_lshlrev_b32 v69, s46, v56
v_lshlrev_b32 v70, s46, v53
v_lshlrev_b32 v71, s46, v57
v_lshlrev_b32 v72, s46, v54
v_lshlrev_b32 v73, s46, v58
v_lshlrev_b32 v74, s46, v55
v_lshlrev_b32 v75, s46, v59
v_and_b32 v68, s31, v68
v_and_b32 v69, s31, v69
v_and_b32 v70, s31, v70
v_and_b32 v71, s31, v71
v_and_b32 v72, s31, v72
v_and_b32 v73, s31, v73
v_and_b32 v74, s31, v74
v_and_b32 v75, s31, v75
v_mul_f32 v69, -v69, v68
v_mul_f32 v71, -v71, v70
v_mul_f32 v73, -v73, v72
v_mul_f32 v75, -v75, v74
s_branch Ljoin
Lkmore:
s_sub_u32 s45, s45, 1
s_cbranch_scc0 Lkpoll
s_branch Lkslow
.p2align 12
Ltouch0:
s_cbranch_execz Lret
Ljoin:
s_waitcnt vmcnt(4) lgkmcnt(0)
s_barrier
buffer_store_dword v250, v252, s[8:11], 0 offen
s_cmp_lg_u32 s28, 0
s_cbranch_scc1 Lkf
buffer_store_dword v250, v253, s[8:11], s55 offen sc1
Lkf:
ds_read_b128 a[0:3], v15 offset:0
ds_read_b128 a[4:7], v15 offset:1088
ds_read_b128 a[8:11], v15 offset:2176
ds_read_b128 a[12:15], v15 offset:3264
ds_read_b128 a[16:19], v15 offset:4352
ds_read_b128 a[20:23], v15 offset:5440
ds_read_b128 a[24:27], v15 offset:6528
ds_read_b128 a[28:31], v15 offset:7616
ds_read_b128 a[32:35], v15 offset:8704
ds_read_b128 a[36:39], v15 offset:9792
ds_read_b128 a[40:43], v15 offset:10880
ds_read_b128 a[44:47], v15 offset:11968
ds_read_b128 a[48:51], v15 offset:13056
s_waitcnt lgkmcnt(9)
ds_read_b128 a[52:55], v15 offset:14144
ds_read_b128 a[56:59], v15 offset:15232
ds_read_b128 a[60:63], v15 offset:16320
s_mov_b32 s45, 15
s_waitcnt lgkmcnt(8)
Lkpoll:
s_load_dwordx4 s[0:3], s[62:63], 0
s_add_u32 s62, s62, 0x800
s_addc_u32 s63, s63, 0
s_waitcnt lgkmcnt(0)
s_xor_b64 s[0:1], s[0:1], s[24:25]
s_xor_b64 s[2:3], s[2:3], s[24:25]
s_or_b64 s[0:1], s[0:1], s[2:3]
s_cbranch_scc1 Lkmore
Lkdone:
global_load_dwordx4 a[116:119], v1, s[16:17] offset:-4096 sc1
global_load_dwordx4 a[120:123], v1, s[16:17] offset:-3072 sc1
global_load_dwordx4 a[124:127], v1, s[16:17] offset:-2048 sc1
global_load_dwordx4 a[128:131], v1, s[16:17] offset:-1024 sc1
global_load_dwordx4 a[132:135], v1, s[16:17] offset:0 sc1
global_load_dwordx4 a[136:139], v1, s[16:17] offset:1024 sc1
global_load_dwordx4 a[140:143], v1, s[16:17] offset:2048 sc1
global_load_dwordx4 a[144:147], v1, s[16:17] offset:3072 sc1
s_waitcnt vmcnt(12)
v_cvt_f32_i32 v36, v36
v_cvt_f32_i32 v37, v37
v_cvt_f32_i32 v38, v38
v_cvt_f32_i32 v39, v39
v_pk_fma_f32 v[36:37], v[36:37], v[68:69], v[68:69] op_sel:[0,0,1] op_sel_hi:[1,0,1]
v_pk_fma_f32 v[38:39], v[38:39], v[68:69], v[68:69] op_sel:[0,0,1] op_sel_hi:[1,0,1]
s_waitcnt vmcnt(11)
v_cvt_f32_i32 v40, v40
v_cvt_f32_i32 v41, v41
v_cvt_f32_i32 v42, v42
v_cvt_f32_i32 v43, v43
v_pk_fma_f32 v[40:41], v[40:41], v[70:71], v[70:71] op_sel:[0,0,1] op_sel_hi:[1,0,1]
v_pk_fma_f32 v[42:43], v[42:43], v[70:71], v[70:71] op_sel:[0,0,1] op_sel_hi:[1,0,1]
v_cvt_pk_bf16_f32 v92, v36, v40
v_cvt_pk_bf16_f32 v94, v38, v42
v_cvt_pk_bf16_f32 v96, v37, v41
v_cvt_pk_bf16_f32 v98, v39, v43
s_waitcnt vmcnt(10)
v_cvt_f32_i32 v44, v44
v_cvt_f32_i32 v45, v45
v_cvt_f32_i32 v46, v46
v_cvt_f32_i32 v47, v47
v_pk_fma_f32 v[44:45], v[44:45], v[72:73], v[72:73] op_sel:[0,0,1] op_sel_hi:[1,0,1]
v_pk_fma_f32 v[46:47], v[46:47], v[72:73], v[72:73] op_sel:[0,0,1] op_sel_hi:[1,0,1]
s_waitcnt vmcnt(9)
v_cvt_f32_i32 v48, v48
v_cvt_f32_i32 v49, v49
v_cvt_f32_i32 v50, v50
v_cvt_f32_i32 v51, v51
v_pk_fma_f32 v[48:49], v[48:49], v[74:75], v[74:75] op_sel:[0,0,1] op_sel_hi:[1,0,1]
v_pk_fma_f32 v[50:51], v[50:51], v[74:75], v[74:75] op_sel:[0,0,1] op_sel_hi:[1,0,1]
v_cvt_pk_bf16_f32 v93, v44, v48
v_cvt_pk_bf16_f32 v95, v46, v50
v_cvt_pk_bf16_f32 v97, v45, v49
v_cvt_pk_bf16_f32 v99, v47, v51
v_permlane32_swap_b32 v92, v94
v_permlane32_swap_b32 v96, v98
v_permlane32_swap_b32 v93, v95
v_permlane32_swap_b32 v97, v99
global_store_dwordx4 v203, v[92:95], s[22:23] offset:0 sc1
global_store_dwordx4 v203, v[96:99], s[22:23] offset:1024 sc1
global_load_dwordx4 a[148:151], v1, s[18:19] offset:-4096 sc1
global_load_dwordx4 a[152:155], v1, s[18:19] offset:-3072 sc1
global_load_dwordx4 a[156:159], v1, s[18:19] offset:-2048 sc1
global_load_dwordx4 a[160:163], v1, s[18:19] offset:-1024 sc1
s_waitcnt vmcnt(13)
v_mfma_f32_16x16x32_bf16 v[16:19], a[116:119], a[0:3], 0
s_waitcnt vmcnt(12)
global_load_dwordx4 a[164:167], v1, s[18:19] offset:0 sc1
global_load_dwordx4 a[168:171], v1, s[18:19] offset:1024 sc1
v_mfma_f32_16x16x32_bf16 v[16:19], a[120:123], a[4:7], v[16:19]
s_waitcnt vmcnt(13)
v_mfma_f32_16x16x32_bf16 v[16:19], a[124:127], a[8:11], v[16:19]
s_waitcnt vmcnt(12)
v_mfma_f32_16x16x32_bf16 v[16:19], a[128:131], a[12:15], v[16:19]
v_mfma_f32_16x16x32_bf16 v[24:27], a[116:119], a[16:19], 0
global_load_dwordx4 a[172:175], v1, s[18:19] offset:2048 sc1
v_mfma_f32_16x16x32_bf16 v[24:27], a[120:123], a[20:23], v[24:27]
v_exp_f32_e64 v16, v16
v_mfma_f32_16x16x32_bf16 v[24:27], a[124:127], a[24:27], v[24:27]
v_exp_f32_e64 v17, v17
v_mfma_f32_16x16x32_bf16 v[24:27], a[128:131], a[28:31], v[24:27]
v_exp_f32_e64 v18, v18
v_mfma_f32_16x16x32_bf16 v[32:35], a[116:119], a[32:35], 0
v_exp_f32_e64 v19, v19
v_mfma_f32_16x16x32_bf16 v[32:35], a[120:123], a[36:39], v[32:35]
v_exp_f32_e64 v24, v24
v_mfma_f32_16x16x32_bf16 v[32:35], a[124:127], a[40:43], v[32:35]
v_exp_f32_e64 v25, v25
v_mfma_f32_16x16x32_bf16 v[32:35], a[128:131], a[44:47], v[32:35]
global_load_dwordx4 a[176:179], v1, s[18:19] offset:3072 sc1
v_cvt_pk_bf16_f32 v176, v16, v17
v_mfma_f32_16x16x32_bf16 v[40:43], a[116:119], a[48:51], 0
v_exp_f32_e64 v26, v26
v_mfma_f32_16x16x32_bf16 v[40:43], a[120:123], a[52:55], v[40:43]
v_exp_f32_e64 v27, v27
v_mfma_f32_16x16x32_bf16 v[40:43], a[124:127], a[56:59], v[40:43]
v_exp_f32_e64 v32, v32
v_mfma_f32_16x16x32_bf16 v[40:43], a[128:131], a[60:63], v[40:43]
s_waitcnt vmcnt(13)
global_load_dwordx4 a[180:183], v1, s[20:21] offset:-4096 sc1
v_cvt_pk_bf16_f32 v177, v18, v19
v_mfma_f32_16x16x32_bf16 v[20:23], a[132:135], a[0:3], 0
s_waitcnt vmcnt(13)
v_exp_f32_e64 v33, v33
v_mfma_f32_16x16x32_bf16 v[20:23], a[136:139], a[4:7], v[20:23]
s_waitcnt vmcnt(12)
v_exp_f32 v34, v34
v_mfma_f32_16x16x32_bf16 v[20:23], a[140:143], a[8:11], v[20:23]
s_waitcnt vmcnt(11)
v_exp_f32 v35, v35
v_mfma_f32_16x16x32_bf16 v[20:23], a[144:147], a[12:15], v[20:23]
global_load_dwordx4 a[184:187], v1, s[20:21] offset:-3072 sc1
v_cvt_pk_bf16_f32 v180, v24, v25
v_mfma_f32_16x16x32_bf16 v[28:31], a[132:135], a[16:19], 0
v_exp_f32_e64 v40, v40
v_mfma_f32_16x16x32_bf16 v[28:31], a[136:139], a[20:23], v[28:31]
v_exp_f32_e64 v41, v41
v_mfma_f32_16x16x32_bf16 v[28:31], a[140:143], a[24:27], v[28:31]
global_load_dwordx4 a[188:191], v1, s[20:21] offset:-2048 sc1
v_cvt_pk_bf16_f32 v181, v26, v27
v_mfma_f32_16x16x32_bf16 v[28:31], a[144:147], a[28:31], v[28:31]
v_exp_f32_e64 v42, v42
v_mfma_f32_16x16x32_bf16 v[36:39], a[132:135], a[32:35], 0
v_exp_f32_e64 v43, v43
v_mfma_f32_16x16x32_bf16 v[36:39], a[136:139], a[36:39], v[36:39]
v_exp_f32_e64 v20, v20
v_mfma_f32_16x16x32_bf16 v[36:39], a[140:143], a[40:43], v[36:39]
global_load_dwordx4 a[192:195], v1, s[20:21] offset:-1024 sc1
v_cvt_pk_bf16_f32 v184, v32, v33
v_mfma_f32_16x16x32_bf16 v[36:39], a[144:147], a[44:47], v[36:39]
v_exp_f32_e64 v21, v21
v_mfma_f32_16x16x32_bf16 v[44:47], a[132:135], a[48:51], 0
v_exp_f32_e64 v22, v22
v_mfma_f32_16x16x32_bf16 v[44:47], a[136:139], a[52:55], v[44:47]
s_waitcnt vmcnt(12)
s_barrier
v_mfma_f32_16x16x32_bf16 v[44:47], a[140:143], a[56:59], v[44:47]
buffer_store_dword v251, v12, s[8:11], s54 offen
s_cmp_lg_u32 s28, 1
s_cbranch_scc1 Lvf
buffer_store_dword v251, v13, s[8:11], s30 offen sc1
Lvf:
v_mfma_f32_16x16x32_bf16 v[44:47], a[144:147], a[60:63], v[44:47]
s_waitcnt vmcnt(12)
global_load_dwordx4 a[196:199], v1, s[20:21] offset:0 sc1
v_cvt_pk_bf16_f32 v185, v34, v35
v_mfma_f32_16x16x32_bf16 v[48:51], a[148:151], a[0:3], 0
s_waitcnt vmcnt(12)
v_exp_f32_e64 v23, v23
v_mfma_f32_16x16x32_bf16 v[48:51], a[152:155], a[4:7], v[48:51]
s_waitcnt vmcnt(11)
v_exp_f32 v28, v28
v_mfma_f32_16x16x32_bf16 v[48:51], a[156:159], a[8:11], v[48:51]
s_waitcnt vmcnt(10)
global_load_dwordx4 a[200:203], v1, s[20:21] offset:1024 sc1
v_cvt_pk_bf16_f32 v188, v40, v41
v_mfma_f32_16x16x32_bf16 v[48:51], a[160:163], a[12:15], v[48:51]
v_exp_f32 v29, v29
v_mfma_f32_16x16x32_bf16 v[56:59], a[148:151], a[16:19], 0
v_exp_f32_e64 v30, v30
v_mfma_f32_16x16x32_bf16 v[56:59], a[152:155], a[20:23], v[56:59]
v_exp_f32_e64 v31, v31
v_mfma_f32_16x16x32_bf16 v[56:59], a[156:159], a[24:27], v[56:59]
global_load_dwordx4 a[204:207], v1, s[20:21] offset:2048 sc1
v_cvt_pk_bf16_f32 v189, v42, v43
v_mfma_f32_16x16x32_bf16 v[56:59], a[160:163], a[28:31], v[56:59]
v_exp_f32_e64 v36, v36
v_mfma_f32_16x16x32_bf16 v[64:67], a[148:151], a[32:35], 0
v_exp_f32_e64 v37, v37
v_mfma_f32_16x16x32_bf16 v[64:67], a[152:155], a[36:39], v[64:67]
v_cvt_pk_bf16_f32 v178, v20, v21
v_cvt_pk_bf16_f32 v179, v22, v23
v_mfma_f32_16x16x32_bf16 v[64:67], a[156:159], a[40:43], v[64:67]
ds_write_b128 v6, v[176:179] offset:0
v_mfma_f32_16x16x32_bf16 v[64:67], a[160:163], a[44:47], v[64:67]
global_load_dwordx4 a[208:211], v1, s[20:21] offset:3072 sc1
v_cvt_pk_bf16_f32 v182, v28, v29
v_mfma_f32_16x16x32_bf16 v[224:227], a[112:115], v[176:179], 0
v_exp_f32_e64 v38, v38
v_mfma_f32_16x16x32_bf16 v[72:75], a[148:151], a[48:51], 0
v_exp_f32_e64 v39, v39
v_mfma_f32_16x16x32_bf16 v[72:75], a[152:155], a[52:55], v[72:75]
global_load_dwordx4 a[212:215], v1, s[34:35] offset:-4096 sc1
v_cvt_pk_bf16_f32 v183, v30, v31
v_mfma_f32_16x16x32_bf16 v[72:75], a[156:159], a[56:59], v[72:75]
ds_write_b128 v6, v[180:183] offset:1024
v_mfma_f32_16x16x32_bf16 v[72:75], a[160:163], a[60:63], v[72:75]
s_waitcnt vmcnt(11)
v_exp_f32 v44, v44
v_mfma_f32_16x16x32_bf16 v[228:231], a[112:115], v[180:183], 0
v_exp_f32_e64 v45, v45
v_mfma_f32_16x16x32_bf16 v[52:55], a[164:167], a[0:3], 0
v_exp_f32_e64 v46, v46
v_mfma_f32_16x16x32_bf16 v[52:55], a[168:171], a[4:7], v[52:55]
global_load_dwordx4 a[216:219], v1, s[34:35] offset:-3072 sc1
v_cvt_pk_bf16_f32 v186, v36, v37
v_mfma_f32_16x16x32_bf16 v[52:55], a[172:175], a[8:11], v[52:55]
s_waitcnt vmcnt(11)
v_exp_f32 v47, v47
v_mfma_f32_16x16x32_bf16 v[52:55], a[176:179], a[12:15], v[52:55]
v_exp_f32_e64 v48, v48
v_mfma_f32_16x16x32_bf16 v[60:63], a[164:167], a[16:19], 0
v_exp_f32_e64 v49, v49
v_mfma_f32_16x16x32_bf16 v[60:63], a[168:171], a[20:23], v[60:63]
global_load_dwordx4 a[220:223], v1, s[34:35] offset:-2048 sc1
v_cvt_pk_bf16_f32 v187, v38, v39
v_mfma_f32_16x16x32_bf16 v[60:63], a[172:175], a[24:27], v[60:63]
buffer_load_dword v242, v249, s[8:11], s51 offen sc1
v_cvt_pk_bf16_f32 v190, v44, v45
v_mfma_f32_16x16x32_bf16 v[60:63], a[176:179], a[28:31], v[60:63]
ds_write_b128 v6, v[184:187] offset:2048
v_mfma_f32_16x16x32_bf16 v[232:235], a[112:115], v[184:187], 0
v_exp_f32_e64 v50, v50
v_mfma_f32_16x16x32_bf16 v[68:71], a[164:167], a[32:35], 0
v_exp_f32_e64 v51, v51
v_mfma_f32_16x16x32_bf16 v[68:71], a[168:171], a[36:39], v[68:71]
global_load_dwordx4 a[224:227], v1, s[34:35] offset:-1024 sc1
v_cvt_pk_bf16_f32 v191, v46, v47
v_mfma_f32_16x16x32_bf16 v[68:71], a[172:175], a[40:43], v[68:71]
ds_write_b128 v6, v[188:191] offset:3072
v_mfma_f32_16x16x32_bf16 v[68:71], a[176:179], a[44:47], v[68:71]
s_load_dwordx4 s[0:3], s[58:59], 0
v_exp_f32_e64 v52, v52
v_mfma_f32_16x16x32_bf16 v[236:239], a[112:115], v[188:191], 0
v_exp_f32_e64 v53, v53
v_mfma_f32_16x16x32_bf16 v[76:79], a[164:167], a[48:51], 0
v_exp_f32_e64 v54, v54
v_mfma_f32_16x16x32_bf16 v[76:79], a[168:171], a[52:55], v[76:79]
global_load_dwordx4 a[228:231], v1, s[34:35] offset:0 sc1
v_cvt_pk_bf16_f32 v192, v48, v49
v_mfma_f32_16x16x32_bf16 v[76:79], a[172:175], a[56:59], v[76:79]
v_exp_f32_e64 v55, v55
v_mfma_f32_16x16x32_bf16 v[76:79], a[176:179], a[60:63], v[76:79]
s_waitcnt vmcnt(12)
v_exp_f32 v56, v56
v_mfma_f32_16x16x32_bf16 v[80:83], a[180:183], a[0:3], 0
s_waitcnt lgkmcnt(0)
s_barrier
v_mfma_f32_16x16x32_bf16 v[80:83], a[184:187], a[4:7], v[80:83]
global_load_dwordx4 a[232:235], v1, s[34:35] offset:1024 sc1
v_cvt_pk_bf16_f32 v193, v50, v51
v_mfma_f32_16x16x32_bf16 v[80:83], a[188:191], a[8:11], v[80:83]
s_waitcnt vmcnt(12)
v_exp_f32 v57, v57
v_mfma_f32_16x16x32_bf16 v[80:83], a[192:195], a[12:15], v[80:83]
v_exp_f32_e64 v58, v58
v_mfma_f32_16x16x32_bf16 v[88:91], a[180:183], a[16:19], 0
global_load_dwordx4 a[236:239], v1, s[34:35] offset:2048 sc1
v_cvt_pk_bf16_f32 v194, v52, v53
v_mfma_f32_16x16x32_bf16 v[88:91], a[184:187], a[20:23], v[88:91]
v_exp_f32_e64 v59, v59
v_mfma_f32_16x16x32_bf16 v[88:91], a[188:191], a[24:27], v[88:91]
v_exp_f32_e64 v60, v60
v_mfma_f32_16x16x32_bf16 v[88:91], a[192:195], a[28:31], v[88:91]
s_waitcnt lgkmcnt(0)
v_exp_f32 v61, v61
v_mfma_f32_16x16x32_bf16 v[96:99], a[180:183], a[32:35], 0
s_xor_b64 s[0:1], s[0:1], s[24:25]
global_load_dwordx4 a[240:243], v1, s[34:35] offset:3072 sc1
v_cvt_pk_bf16_f32 v195, v54, v55
v_mfma_f32_16x16x32_bf16 v[96:99], a[184:187], a[36:39], v[96:99]
s_xor_b64 s[2:3], s[2:3], s[24:25]
ds_write_b128 v6, v[192:195] offset:16384
v_mfma_f32_16x16x32_bf16 v[96:99], a[188:191], a[40:43], v[96:99]
s_or_b64 s[0:1], s[0:1], s[2:3]
v_exp_f32 v62, v62
v_mfma_f32_16x16x32_bf16 v[96:99], a[192:195], a[44:47], v[96:99]
s_cbranch_scc1 Lv0slow
Lv0back:
v_cvt_pk_bf16_f32 v196, v56, v57
v_mfma_f32_16x16x32_bf16 v[224:227], a[112:115], v[192:195], v[224:227]
v_exp_f32 v63, v63
v_mfma_f32_16x16x32_bf16 v[104:107], a[180:183], a[48:51], 0
global_load_dwordx4 a[116:119], v2, s[16:17] offset:0 sc1
v_cvt_pk_bf16_f32 v197, v58, v59
v_mfma_f32_16x16x32_bf16 v[104:107], a[184:187], a[52:55], v[104:107]
v_exp_f32_e64 v64, v64
v_mfma_f32_16x16x32_bf16 v[104:107], a[188:191], a[56:59], v[104:107]
v_exp_f32_e64 v65, v65
v_mfma_f32_16x16x32_bf16 v[104:107], a[192:195], a[60:63], v[104:107]
s_waitcnt vmcnt(11)
v_exp_f32 v66, v66
v_mfma_f32_16x16x32_bf16 v[84:87], a[196:199], a[0:3], 0
global_load_dwordx4 a[120:123], v3, s[16:17] offset:0 sc1
v_cvt_pk_bf16_f32 v198, v60, v61
v_mfma_f32_16x16x32_bf16 v[84:87], a[200:203], a[4:7], v[84:87]
v_exp_f32_e64 v67, v67
v_mfma_f32_16x16x32_bf16 v[84:87], a[204:207], a[8:11], v[84:87]
s_waitcnt vmcnt(11)
v_exp_f32 v68, v68
v_mfma_f32_16x16x32_bf16 v[84:87], a[208:211], a[12:15], v[84:87]
v_exp_f32_e64 v69, v69
v_mfma_f32_16x16x32_bf16 v[92:95], a[196:199], a[16:19], 0
global_load_dwordx4 a[124:127], v4, s[16:17] offset:0 sc1
buffer_load_dword v241, v248, s[8:11], 0 offen sc1
v_mfma_f32_16x16x32_bf16 v[92:95], a[200:203], a[20:23], v[92:95]
v_exp_f32_e64 v70, v70
v_mfma_f32_16x16x32_bf16 v[92:95], a[204:207], a[24:27], v[92:95]
v_exp_f32_e64 v71, v71
v_mfma_f32_16x16x32_bf16 v[92:95], a[208:211], a[28:31], v[92:95]
v_cvt_pk_bf16_f32 v199, v62, v63
v_cvt_pk_bf16_f32 v200, v64, v65
v_mfma_f32_16x16x32_bf16 v[100:103], a[196:199], a[32:35], 0
ds_write_b128 v6, v[196:199] offset:17408
v_mfma_f32_16x16x32_bf16 v[100:103], a[200:203], a[36:39], v[100:103]
global_load_dwordx4 a[128:131], v5, s[16:17] offset:0 sc1
v_cvt_pk_bf16_f32 v201, v66, v67
v_mfma_f32_16x16x32_bf16 v[100:103], a[204:207], a[40:43], v[100:103]
v_exp_f32_e64 v72, v72
v_mfma_f32_16x16x32_bf16 v[100:103], a[208:211], a[44:47], v[100:103]
global_load_dwordx4 a[132:135], v2, s[16:17] offset:1024 sc1
ds_read_b128 a[64:67], v7 offset:0
v_mfma_f32_16x16x32_bf16 v[228:231], a[112:115], v[196:199], v[228:231]
v_exp_f32_e64 v73, v73
v_mfma_f32_16x16x32_bf16 v[108:111], a[196:199], a[48:51], 0
v_exp_f32_e64 v74, v74
v_mfma_f32_16x16x32_bf16 v[108:111], a[200:203], a[52:55], v[108:111]
ds_read_b128 a[68:71], v8 offset:0
v_cvt_pk_bf16_f32 v202, v68, v69
v_mfma_f32_16x16x32_bf16 v[108:111], a[204:207], a[56:59], v[108:111]
v_exp_f32_e64 v75, v75
v_mfma_f32_16x16x32_bf16 v[108:111], a[208:211], a[60:63], v[108:111]
s_waitcnt vmcnt(12)
global_load_dwordx4 a[136:139], v3, s[16:17] offset:1024 sc1
v_cvt_pk_bf16_f32 v203, v70, v71
v_mfma_f32_16x16x32_bf16 v[112:115], a[212:215], a[0:3], 0
ds_write_b128 v6, v[200:203] offset:18432
v_mfma_f32_16x16x32_bf16 v[112:115], a[216:219], a[4:7], v[112:115]
v_exp_f32 v76, v76
v_mfma_f32_16x16x32_bf16 v[112:115], a[220:223], a[8:11], v[112:115]
s_waitcnt vmcnt(11)
v_exp_f32 v77, v77
v_mfma_f32_16x16x32_bf16 v[112:115], a[224:227], a[12:15], v[112:115]
global_load_dwordx4 a[140:143], v4, s[16:17] offset:1024 sc1
ds_read_b128 a[72:75], v9 offset:0
v_mfma_f32_16x16x32_bf16 v[232:235], a[112:115], v[200:203], v[232:235]
v_exp_f32_e64 v78, v78
v_mfma_f32_16x16x32_bf16 v[120:123], a[212:215], a[16:19], 0
v_exp_f32_e64 v79, v79
v_mfma_f32_16x16x32_bf16 v[120:123], a[216:219], a[20:23], v[120:123]
ds_read_b128 a[76:79], v7 offset:1024
v_cvt_pk_bf16_f32 v204, v72, v73
v_mfma_f32_16x16x32_bf16 v[120:123], a[220:223], a[24:27], v[120:123]
v_exp_f32_e64 v80, v80
v_mfma_f32_16x16x32_bf16 v[120:123], a[224:227], a[28:31], v[120:123]
global_load_dwordx4 a[144:147], v5, s[16:17] offset:1024 sc1
v_cvt_pk_bf16_f32 v205, v74, v75
v_mfma_f32_16x16x32_bf16 v[128:131], a[212:215], a[32:35], 0
v_cmp_ne_u32 vcc, s24, v242
v_cvt_pk_bf16_f32 v206, v76, v77
v_mfma_f32_16x16x32_bf16 v[128:131], a[216:219], a[36:39], v[128:131]
ds_read_b128 a[80:83], v8 offset:1024
v_cvt_pk_bf16_f32 v207, v78, v79
v_mfma_f32_16x16x32_bf16 v[128:131], a[220:223], a[40:43], v[128:131]
s_cbranch_vccnz Lrkslow
Lrkback:
ds_read_b128 a[84:87], v9 offset:1024
v_mfma_f32_16x16x32_bf16 v[128:131], a[224:227], a[44:47], v[128:131]
ds_write_b128 v6, v[204:207] offset:19456
v_mfma_f32_16x16x32_bf16 v[236:239], a[112:115], v[204:207], v[236:239]
v_exp_f32_e64 v81, v81
v_mfma_f32_16x16x32_bf16 v[136:139], a[212:215], a[48:51], 0
global_load_dwordx4 a[148:151], v1, s[36:37] offset:-4096 sc1
v_cvt_pk_bf16_f32 v208, v80, v81
v_mfma_f32_16x16x32_bf16 v[136:139], a[216:219], a[52:55], v[136:139]
v_exp_f32_e64 v82, v82
v_mfma_f32_16x16x32_bf16 v[136:139], a[220:223], a[56:59], v[136:139]
global_load_dwordx4 a[152:155], v1, s[36:37] offset:-3072 sc1
ds_read_b128 a[88:91], v7 offset:2048
v_mfma_f32_16x16x32_bf16 v[136:139], a[224:227], a[60:63], v[136:139]
s_waitcnt vmcnt(11) lgkmcnt(4)
v_exp_f32 v83, v83
v_mfma_f32_16x16x32_bf16 v[116:119], a[228:231], a[0:3], 0
v_exp_f32_e64 v84, v84
v_mfma_f32_16x16x32_bf16 v[116:119], a[232:235], a[4:7], v[116:119]
s_waitcnt lgkmcnt(1)
s_barrier
v_mfma_f32_16x16x32_bf16 v[116:119], a[236:239], a[8:11], v[116:119]
global_load_dwordx4 a[156:159], v1, s[36:37] offset:-2048 sc1
v_cvt_pk_bf16_f32 v209, v82, v83
v_mfma_f32_16x16x32_bf16 v[116:119], a[240:243], a[12:15], v[116:119]
v_exp_f32_e64 v85, v85
v_mfma_f32_16x16x32_bf16 v[124:127], a[228:231], a[16:19], 0
v_exp_f32_e64 v86, v86
v_mfma_f32_16x16x32_bf16 v[124:127], a[232:235], a[20:23], v[124:127]
ds_read_b128 a[92:95], v8 offset:2048
v_cvt_pk_bf16_f32 v210, v84, v85
v_mfma_f32_16x16x32_bf16 v[124:127], a[236:239], a[24:27], v[124:127]
global_load_dwordx4 a[160:163], v1, s[36:37] offset:-1024 sc1
ds_read_b128 a[96:99], v9 offset:2048
v_mfma_f32_16x16x32_bf16 v[124:127], a[240:243], a[28:31], v[124:127]
v_exp_f32_e64 v87, v87
v_mfma_f32_16x16x32_bf16 v[132:135], a[228:231], a[32:35], 0
v_exp_f32_e64 v88, v88
v_mfma_f32_16x16x32_bf16 v[132:135], a[232:235], a[36:39], v[132:135]
v_exp_f32_e64 v89, v89
v_mfma_f32_16x16x32_bf16 v[132:135], a[236:239], a[40:43], v[132:135]
global_load_dwordx4 a[164:167], v1, s[36:37] offset:0 sc1
v_cvt_pk_bf16_f32 v211, v86, v87
v_mfma_f32_16x16x32_bf16 v[132:135], a[240:243], a[44:47], v[132:135]
ds_write_b128 v6, v[208:211] offset:32768
v_mfma_f32_16x16x32_bf16 v[224:227], a[112:115], v[208:211], v[224:227]
v_exp_f32_e64 v90, v90
v_mfma_f32_16x16x32_bf16 v[140:143], a[228:231], a[48:51], 0
v_exp_f32_e64 v91, v91
v_mfma_f32_16x16x32_bf16 v[140:143], a[232:235], a[52:55], v[140:143]
ds_read_b128 a[100:103], v7 offset:3072
v_cvt_pk_bf16_f32 v212, v88, v89
v_mfma_f32_16x16x32_bf16 v[140:143], a[236:239], a[56:59], v[140:143]
global_load_dwordx4 a[168:171], v1, s[36:37] offset:1024 sc1
v_cvt_pk_bf16_f32 v213, v90, v91
v_mfma_f32_16x16x32_bf16 v[140:143], a[240:243], a[60:63], v[140:143]
s_waitcnt vmcnt(12) lgkmcnt(2)
v_exp_f32 v92, v92
v_mfma_f32_16x16x32_bf16 v[144:147], v[176:179], a[116:119], 0
v_exp_f32_e64 v93, v93
v_mfma_f32_16x16x32_bf16 v[144:147], a[64:67], a[120:123], v[144:147]
ds_read_b128 a[104:107], v8 offset:3072
v_cvt_pk_bf16_f32 v214, v92, v93
v_mfma_f32_16x16x32_bf16 v[144:147], a[68:71], a[124:127], v[144:147]
s_waitcnt vmcnt(9)
global_load_dwordx4 a[172:175], v1, s[36:37] offset:2048 sc1
global_load_dwordx4 a[176:179], v1, s[36:37] offset:3072 sc1
v_mfma_f32_16x16x32_bf16 v[144:147], a[72:75], a[128:131], v[144:147]
v_exp_f32 v94, v94
v_mfma_f32_16x16x32_bf16 v[152:155], v[180:183], a[116:119], 0
v_exp_f32_e64 v95, v95
v_mfma_f32_16x16x32_bf16 v[152:155], a[76:79], a[120:123], v[152:155]
ds_read_b128 a[108:111], v9 offset:3072
v_cvt_pk_bf16_f32 v215, v94, v95
v_mfma_f32_16x16x32_bf16 v[152:155], a[80:83], a[124:127], v[152:155]
v_subrev_u32 v241, s24, v241
v_cmp_lt_u32 vcc, 7, v241
v_mfma_f32_16x16x32_bf16 v[152:155], a[84:87], a[128:131], v[152:155]
ds_write_b128 v6, v[212:215] offset:33792
v_mfma_f32_16x16x32_bf16 v[228:231], a[112:115], v[212:215], v[228:231]
v_exp_f32_e64 v96, v96
v_mfma_f32_16x16x32_bf16 v[160:163], v[184:187], a[116:119], 0
s_cbranch_vccnz Lvlslow
Lvlback:
v_readlane_b32 s60, v241, 32
v_mfma_f32_16x16x32_bf16 v[160:163], a[88:91], a[120:123], v[160:163]
v_exp_f32 v97, v97
v_mfma_f32_16x16x32_bf16 v[160:163], a[92:95], a[124:127], v[160:163]
global_load_dwordx4 a[180:183], v2, s[18:19] offset:0 sc1
v_cvt_pk_bf16_f32 v216, v96, v97
v_mfma_f32_16x16x32_bf16 v[160:163], a[96:99], a[128:131], v[160:163]
v_and_b32 v12, 15, v0
v_and_b32 v13, 48, v0
v_mfma_f32_16x16x32_bf16 v[168:171], v[188:191], a[116:119], 0
s_waitcnt vmcnt(10) lgkmcnt(1)
v_lshlrev_b32 v13, 6, v13
v_lshl_add_u32 v12, v12, 2, v13
v_mfma_f32_16x16x32_bf16 v[168:171], a[100:103], a[120:123], v[168:171]
v_add_u32 v12, s57, v12
v_add_u32 v13, 4096, v12
v_mfma_f32_16x16x32_bf16 v[168:171], a[104:107], a[124:127], v[168:171]
v_exp_f32 v98, v98
v_mfma_f32_16x16x32_bf16 v[168:171], a[108:111], a[128:131], v[168:171]
v_exp_f32_e64 v99, v99
v_mfma_f32_16x16x32_bf16 v[148:151], v[176:179], a[132:135], 0
global_load_dwordx4 a[184:187], v3, s[18:19] offset:0 sc1
v_lshrrev_b32 v14, 2, v0
v_and_b32 v15, 48, v11
v_mfma_f32_16x16x32_bf16 v[148:151], a[64:67], a[136:139], v[148:151]
v_lshl_add_u32 v14, v14, 8, v15
v_add_u32 v15, 4096, v14
v_mfma_f32_16x16x32_bf16 v[148:151], a[68:71], a[140:143], v[148:151]
s_waitcnt vmcnt(10)
s_xor_b32 s61, s57, 8192
v_mov_b32 v252, -1
v_mov_b32_e64 v253, -1
v_mfma_f32_16x16x32_bf16 v[148:151], a[72:75], a[144:147], v[148:151]
v_mov_b32 v254, -1
v_mov_b32 v255, -1
v_mfma_f32_16x16x32_bf16 v[156:159], v[180:183], a[132:135], 0
global_load_dwordx4 a[188:191], v4, s[18:19] offset:0 sc1
v_cvt_pk_bf16_f32 v217, v98, v99
v_mfma_f32_16x16x32_bf16 v[156:159], a[76:79], a[136:139], v[156:159]
global_load_dwordx4 a[192:195], v5, s[18:19] offset:0 sc1
ds_read_b128 a[64:67], v7 offset:16384
v_mfma_f32_16x16x32_bf16 v[156:159], a[80:83], a[140:143], v[156:159]
buffer_store_dwordx4 v[252:255], v14, s[12:15], s61 offen sc1
v_mfma_f32_16x16x32_bf16 v[156:159], a[84:87], a[144:147], v[156:159]
buffer_store_dwordx4 v[252:255], v15, s[12:15], s61 offen sc1
v_mfma_f32_16x16x32_bf16 v[164:167], v[184:187], a[132:135], 0
v_exp_f32_e64 v100, v100
v_mfma_f32_16x16x32_bf16 v[164:167], a[88:91], a[136:139], v[164:167]
s_and_b32 s45, s28, 1
global_load_dwordx4 a[196:199], v2, s[18:19] offset:1024 sc1
global_load_dwordx4 a[200:203], v3, s[18:19] offset:1024 sc1
v_mfma_f32_16x16x32_bf16 v[164:167], a[92:95], a[140:143], v[164:167]
s_lshl_b32 s45, s45, 12
v_and_b32_e64 v252, 15, v0
v_lshl_add_u32 v252, v252, 8, s45
v_mfma_f32_16x16x32_bf16 v[164:167], a[96:99], a[144:147], v[164:167]
v_exp_f32_e64 v101, v101
v_mfma_f32_16x16x32_bf16 v[172:175], v[188:191], a[132:135], 0
v_exp_f32_e64 v102, v102
v_mfma_f32_16x16x32_bf16 v[172:175], a[100:103], a[136:139], v[172:175]
ds_read_b128 a[68:71], v8 offset:16384
v_cvt_pk_bf16_f32 v218, v100, v101
v_mfma_f32_16x16x32_bf16 v[172:175], a[104:107], a[140:143], v[172:175]
v_exp_f32_e64 v103, v103
v_mfma_f32_16x16x32_bf16 v[172:175], a[108:111], a[144:147], v[172:175]
s_waitcnt vmcnt(12)
v_exp_f32 v104, v104
v_mfma_f32_16x16x32_bf16 v[16:19], a[148:151], a[0:3], 0
global_load_dwordx4 a[204:207], v4, s[18:19] offset:1024 sc1
v_cvt_pk_bf16_f32 v219, v102, v103
v_mfma_f32_16x16x32_bf16 v[16:19], a[152:155], a[4:7], v[16:19]
ds_write_b128 v6, v[216:219] offset:34816
v_mfma_f32_16x16x32_bf16 v[16:19], a[156:159], a[8:11], v[16:19]
v_exp_f32_e64 v105, v105
v_mfma_f32_16x16x32_bf16 v[16:19], a[160:163], a[12:15], v[16:19]
v_exp_f32_e64 v106, v106
v_mfma_f32_16x16x32_bf16 v[232:235], a[112:115], v[216:219], v[232:235]
ds_read_b128 a[72:75], v9 offset:16384
v_cvt_pk_bf16_f32 v220, v104, v105
v_mfma_f32_16x16x32_bf16 v[24:27], a[148:151], a[16:19], 0
global_load_dwordx4 a[208:211], v5, s[18:19] offset:1024 sc1
ds_read_b128 a[76:79], v7 offset:17408
v_mfma_f32_16x16x32_bf16 v[24:27], a[152:155], a[20:23], v[24:27]
v_exp_f32_e64 v107, v107
v_mfma_f32_16x16x32_bf16 v[24:27], a[156:159], a[24:27], v[24:27]
v_exp_f32_e64 v108, v108
v_mfma_f32_16x16x32_bf16 v[24:27], a[160:163], a[28:31], v[24:27]
v_exp_f32_e64 v109, v109
v_mfma_f32_16x16x32_bf16 v[32:35], a[148:151], a[32:35], 0
global_load_dwordx4 a[212:215], v1, s[38:39] offset:-4096 sc1
v_cvt_pk_bf16_f32 v221, v106, v107
v_mfma_f32_16x16x32_bf16 v[32:35], a[152:155], a[36:39], v[32:35]
ds_read_b128 a[80:83], v8 offset:17408
v_cvt_pk_bf16_f32 v222, v108, v109
v_mfma_f32_16x16x32_bf16 v[32:35], a[156:159], a[40:43], v[32:35]
v_exp_f32_e64 v110, v110
v_mfma_f32_16x16x32_bf16 v[32:35], a[160:163], a[44:47], v[32:35]
v_exp_f32_e64 v111, v111
v_mfma_f32_16x16x32_bf16 v[40:43], a[148:151], a[48:51], 0
global_load_dwordx4 a[216:219], v1, s[38:39] offset:-3072 sc1
v_cvt_pk_bf16_f32 v223, v110, v111
v_mfma_f32_16x16x32_bf16 v[40:43], a[152:155], a[52:55], v[40:43]
ds_write_b128 v6, v[220:223] offset:35840
v_mfma_f32_16x16x32_bf16 v[40:43], a[156:159], a[56:59], v[40:43]
v_exp_f32_e64 v112, v112
v_mfma_f32_16x16x32_bf16 v[40:43], a[160:163], a[60:63], v[40:43]
s_waitcnt vmcnt(12) lgkmcnt(2)
v_exp_f32 v113, v113
v_mfma_f32_16x16x32_bf16 v[236:239], a[112:115], v[220:223], v[236:239]
ds_read_b128 a[84:87], v9 offset:17408
v_cvt_pk_bf16_f32 v176, v112, v113
v_mfma_f32_16x16x32_bf16 v[20:23], a[164:167], a[0:3], 0
Ltouch1:
s_cbranch_execz Lret
s_nop 0
global_load_dwordx4 a[220:223], v1, s[38:39] offset:-2048 sc1
global_load_dwordx4 a[224:227], v1, s[38:39] offset:-1024 sc1
v_mfma_f32_16x16x32_bf16 v[20:23], a[168:171], a[4:7], v[20:23]
v_exp_f32_e64 v114, v114
v_mfma_f32_16x16x32_bf16 v[20:23], a[172:175], a[8:11], v[20:23]
v_exp_f32_e64 v115, v115
v_mfma_f32_16x16x32_bf16 v[20:23], a[176:179], a[12:15], v[20:23]
s_waitcnt lgkmcnt(1)
s_barrier
v_mfma_f32_16x16x32_bf16 v[28:31], a[164:167], a[16:19], 0
ds_read_b128 a[88:91], v7 offset:18432
v_cvt_pk_bf16_f32 v177, v114, v115
v_mfma_f32_16x16x32_bf16 v[28:31], a[168:171], a[20:23], v[28:31]
ds_read_b128 a[92:95], v8 offset:18432
global_load_dwordx4 a[228:231], v1, s[38:39] offset:0 sc1
v_mfma_f32_16x16x32_bf16 v[28:31], a[172:175], a[24:27], v[28:31]
v_exp_f32_e64 v116, v116
v_mfma_f32_16x16x32_bf16 v[28:31], a[176:179], a[28:31], v[28:31]
v_exp_f32_e64 v117, v117
v_mfma_f32_16x16x32_bf16 v[36:39], a[164:167], a[32:35], 0
v_exp_f32_e64 v118, v118
v_mfma_f32_16x16x32_bf16 v[36:39], a[168:171], a[36:39], v[36:39]
ds_read_b128 a[96:99], v9 offset:18432
v_cvt_pk_bf16_f32 v178, v116, v117
v_mfma_f32_16x16x32_bf16 v[36:39], a[172:175], a[40:43], v[36:39]
v_exp_f32_e64 v119, v119
v_mfma_f32_16x16x32_bf16 v[36:39], a[176:179], a[44:47], v[36:39]
global_load_dwordx4 a[232:235], v1, s[38:39] offset:1024 sc1
v_cvt_pk_bf16_f32 v179, v118, v119
v_mfma_f32_16x16x32_bf16 v[44:47], a[164:167], a[48:51], 0
ds_write_b128 v6, v[176:179] offset:49152
v_mfma_f32_16x16x32_bf16 v[44:47], a[168:171], a[52:55], v[44:47]
v_exp_f32_e64 v120, v120
v_mfma_f32_16x16x32_bf16 v[44:47], a[172:175], a[56:59], v[44:47]
v_exp_f32_e64 v121, v121
v_mfma_f32_16x16x32_bf16 v[44:47], a[176:179], a[60:63], v[44:47]
s_waitcnt vmcnt(12) lgkmcnt(2)
global_load_dwordx4 a[236:239], v1, s[38:39] offset:2048 sc1
ds_read_b128 a[100:103], v7 offset:19456
v_mfma_f32_16x16x32_bf16 v[224:227], a[112:115], v[176:179], v[224:227]
v_exp_f32 v122, v122
v_mfma_f32_16x16x32_bf16 v[144:147], v[192:195], a[180:183], v[144:147]
v_exp_f32_e64 v123, v123
v_mfma_f32_16x16x32_bf16 v[144:147], a[64:67], a[184:187], v[144:147]
ds_read_b128 a[104:107], v8 offset:19456
v_cvt_pk_bf16_f32 v180, v120, v121
v_mfma_f32_16x16x32_bf16 v[144:147], a[68:71], a[188:191], v[144:147]
v_exp_f32_e64 v124, v124
v_mfma_f32_16x16x32_bf16 v[144:147], a[72:75], a[192:195], v[144:147]
global_load_dwordx4 a[240:243], v1, s[38:39] offset:3072 sc1
v_cvt_pk_bf16_f32 v181, v122, v123
v_mfma_f32_16x16x32_bf16 v[152:155], v[196:199], a[180:183], v[152:155]
v_exp_f32_e64 v125, v125
v_mfma_f32_16x16x32_bf16 v[152:155], a[76:79], a[184:187], v[152:155]
ds_read_b128 a[108:111], v9 offset:19456
v_cvt_pk_bf16_f32 v182, v124, v125
v_mfma_f32_16x16x32_bf16 v[152:155], a[80:83], a[188:191], v[152:155]
v_exp_f32_e64 v126, v126
v_mfma_f32_16x16x32_bf16 v[152:155], a[84:87], a[192:195], v[152:155]
v_exp_f32_e64 v127, v127
v_mfma_f32_16x16x32_bf16 v[160:163], v[200:203], a[180:183], v[160:163]
global_load_dwordx4 a[116:119], v2, s[20:21] offset:0 sc1
v_cvt_pk_bf16_f32 v183, v126, v127
v_mfma_f32_16x16x32_bf16 v[160:163], a[88:91], a[184:187], v[160:163]
ds_write_b128 v6, v[180:183] offset:50176
v_mfma_f32_16x16x32_bf16 v[160:163], a[92:95], a[188:191], v[160:163]
s_waitcnt vmcnt(10) lgkmcnt(2)
v_exp_f32 v128, v128
v_mfma_f32_16x16x32_bf16 v[160:163], a[96:99], a[192:195], v[160:163]
v_exp_f32_e64 v129, v129
v_mfma_f32_16x16x32_bf16 v[228:231], a[112:115], v[180:183], v[228:231]
global_load_dwordx4 a[120:123], v3, s[20:21] offset:0 sc1
v_cvt_pk_bf16_f32 v184, v128, v129
v_mfma_f32_16x16x32_bf16 v[168:171], v[204:207], a[180:183], v[168:171]
v_exp_f32_e64 v130, v130
v_mfma_f32_16x16x32_bf16 v[168:171], a[100:103], a[184:187], v[168:171]
v_exp_f32_e64 v131, v131
v_mfma_f32_16x16x32_bf16 v[168:171], a[104:107], a[188:191], v[168:171]
s_waitcnt vmcnt(10) lgkmcnt(1)
global_load_dwordx4 a[124:127], v4, s[20:21] offset:0 sc1
v_cvt_pk_bf16_f32 v185, v130, v131
v_mfma_f32_16x16x32_bf16 v[168:171], a[108:111], a[192:195], v[168:171]
v_exp_f32 v132, v132
v_mfma_f32_16x16x32_bf16 v[148:151], v[192:195], a[196:199], v[148:151]
v_exp_f32_e64 v133, v133
v_mfma_f32_16x16x32_bf16 v[148:151], a[64:67], a[200:203], v[148:151]
v_exp_f32_e64 v134, v134
v_mfma_f32_16x16x32_bf16 v[148:151], a[68:71], a[204:207], v[148:151]
global_load_dwordx4 a[128:131], v5, s[20:21] offset:0 sc1
v_cvt_pk_bf16_f32 v186, v132, v133
v_mfma_f32_16x16x32_bf16 v[148:151], a[72:75], a[208:211], v[148:151]
v_exp_f32_e64 v135, v135
v_mfma_f32_16x16x32_bf16 v[156:159], v[196:199], a[196:199], v[156:159]
v_exp_f32_e64 v136, v136
v_mfma_f32_16x16x32_bf16 v[156:159], a[76:79], a[200:203], v[156:159]
v_exp_f32_e64 v137, v137
v_mfma_f32_16x16x32_bf16 v[156:159], a[80:83], a[204:207], v[156:159]
global_load_dwordx4 a[132:135], v2, s[20:21] offset:1024 sc1
v_cvt_pk_bf16_f32 v187, v134, v135
v_mfma_f32_16x16x32_bf16 v[156:159], a[84:87], a[208:211], v[156:159]
ds_write_b128 v6, v[184:187] offset:51200
v_mfma_f32_16x16x32_bf16 v[232:235], a[112:115], v[184:187], v[232:235]
v_exp_f32_e64 v138, v138
v_mfma_f32_16x16x32_bf16 v[164:167], v[200:203], a[196:199], v[164:167]
v_exp_f32_e64 v139, v139
v_mfma_f32_16x16x32_bf16 v[164:167], a[88:91], a[200:203], v[164:167]
ds_read_b128 a[64:67], v7 offset:32768
v_cvt_pk_bf16_f32 v188, v136, v137
v_mfma_f32_16x16x32_bf16 v[164:167], a[92:95], a[204:207], v[164:167]
global_load_dwordx4 a[136:139], v3, s[20:21] offset:1024 sc1
v_cvt_pk_bf16_f32 v189, v138, v139
v_mfma_f32_16x16x32_bf16 v[164:167], a[96:99], a[208:211], v[164:167]
v_exp_f32_e64 v140, v140
v_mfma_f32_16x16x32_bf16 v[172:175], v[204:207], a[196:199], v[172:175]
v_exp_f32_e64 v141, v141
v_mfma_f32_16x16x32_bf16 v[172:175], a[100:103], a[200:203], v[172:175]
global_load_dwordx4 a[140:143], v4, s[20:21] offset:1024 sc1
ds_read_b128 a[68:71], v8 offset:32768
v_mfma_f32_16x16x32_bf16 v[172:175], a[104:107], a[204:207], v[172:175]
v_exp_f32_e64 v142, v142
v_mfma_f32_16x16x32_bf16 v[172:175], a[108:111], a[208:211], v[172:175]
s_waitcnt vmcnt(10)
v_exp_f32 v143, v143
v_mfma_f32_16x16x32_bf16 v[48:51], a[212:215], a[0:3], 0
v_exp_f32_e64 v16, v16
v_mfma_f32_16x16x32_bf16 v[48:51], a[216:219], a[4:7], v[48:51]
global_load_dwordx4 a[144:147], v5, s[20:21] offset:1024 sc1
ds_read_b128 a[72:75], v9 offset:32768
v_mfma_f32_16x16x32_bf16 v[48:51], a[220:223], a[8:11], v[48:51]
v_exp_f32_e64 v17, v17
v_mfma_f32_16x16x32_bf16 v[48:51], a[224:227], a[12:15], v[48:51]
v_exp_f32_e64 v18, v18
v_mfma_f32_16x16x32_bf16 v[56:59], a[212:215], a[16:19], 0
v_exp_f32_e64 v19, v19
v_mfma_f32_16x16x32_bf16 v[56:59], a[216:219], a[20:23], v[56:59]
global_load_dwordx4 a[148:151], v1, s[40:41] offset:-4096 sc1
ds_read_b128 a[76:79], v7 offset:33792
v_mfma_f32_16x16x32_bf16 v[56:59], a[220:223], a[24:27], v[56:59]
v_exp_f32_e64 v20, v20
v_mfma_f32_16x16x32_bf16 v[56:59], a[224:227], a[28:31], v[56:59]
v_exp_f32_e64 v21, v21
v_mfma_f32_16x16x32_bf16 v[64:67], a[212:215], a[32:35], 0
v_cvt_pk_bf16_f32 v190, v140, v141
v_cvt_pk_bf16_f32 v191, v142, v143
v_mfma_f32_16x16x32_bf16 v[64:67], a[216:219], a[36:39], v[64:67]
ds_write_b128 v6, v[188:191] offset:52224
v_mfma_f32_16x16x32_bf16 v[64:67], a[220:223], a[40:43], v[64:67]
global_load_dwordx4 a[152:155], v1, s[40:41] offset:-3072 sc1
v_cvt_pk_bf16_f32 v192, v16, v17
v_mfma_f32_16x16x32_bf16 v[64:67], a[224:227], a[44:47], v[64:67]
v_exp_f32_e64 v22, v22
v_mfma_f32_16x16x32_bf16 v[236:239], a[112:115], v[188:191], v[236:239]
ds_read_b128 a[80:83], v8 offset:33792
v_cvt_pk_bf16_f32 v193, v18, v19
v_mfma_f32_16x16x32_bf16 v[72:75], a[212:215], a[48:51], 0
v_exp_f32_e64 v23, v23
v_mfma_f32_16x16x32_bf16 v[72:75], a[216:219], a[52:55], v[72:75]
global_load_dwordx4 a[156:159], v1, s[40:41] offset:-2048 sc1
ds_read_b128 a[84:87], v9 offset:33792
v_mfma_f32_16x16x32_bf16 v[72:75], a[220:223], a[56:59], v[72:75]
v_exp_f32_e64 v24, v24
v_mfma_f32_16x16x32_bf16 v[72:75], a[224:227], a[60:63], v[72:75]
s_waitcnt lgkmcnt(2)
s_barrier
v_mfma_f32_16x16x32_bf16 v[52:55], a[228:231], a[0:3], 0
s_waitcnt vmcnt(10)
v_exp_f32 v25, v25
v_mfma_f32_16x16x32_bf16 v[52:55], a[232:235], a[4:7], v[52:55]
global_load_dwordx4 a[160:163], v1, s[40:41] offset:-1024 sc1
ds_read_b128 a[88:91], v7 offset:34816
v_mfma_f32_16x16x32_bf16 v[52:55], a[236:239], a[8:11], v[52:55]
v_exp_f32_e64 v26, v26
v_mfma_f32_16x16x32_bf16 v[52:55], a[240:243], a[12:15], v[52:55]
v_exp_f32_e64 v27, v27
v_mfma_f32_16x16x32_bf16 v[60:63], a[228:231], a[16:19], 0
global_load_dwordx4 a[164:167], v1, s[40:41] offset:0 sc1
v_cvt_pk_bf16_f32 v194, v20, v21
v_mfma_f32_16x16x32_bf16 v[60:63], a[232:235], a[20:23], v[60:63]
ds_read_b128 a[92:95], v8 offset:34816
v_cvt_pk_bf16_f32 v195, v22, v23
v_mfma_f32_16x16x32_bf16 v[60:63], a[236:239], a[24:27], v[60:63]
ds_write_b128 v6, v[192:195] offset:0
v_mfma_f32_16x16x32_bf16 v[60:63], a[240:243], a[28:31], v[60:63]
v_exp_f32_e64 v28, v28
v_mfma_f32_16x16x32_bf16 v[224:227], a[112:115], v[192:195], v[224:227]
v_exp_f32_e64 v29, v29
v_mfma_f32_16x16x32_bf16 v[68:71], a[228:231], a[32:35], 0
global_load_dwordx4 a[168:171], v1, s[40:41] offset:1024 sc1
v_cvt_pk_bf16_f32 v196, v24, v25
v_mfma_f32_16x16x32_bf16 v[68:71], a[232:235], a[36:39], v[68:71]
ds_read_b128 a[96:99], v9 offset:34816
v_cvt_pk_bf16_f32 v197, v26, v27
v_mfma_f32_16x16x32_bf16 v[68:71], a[236:239], a[40:43], v[68:71]
v_exp_f32_e64 v30, v30
v_mfma_f32_16x16x32_bf16 v[68:71], a[240:243], a[44:47], v[68:71]
v_exp_f32_e64 v31, v31
v_mfma_f32_16x16x32_bf16 v[76:79], a[228:231], a[48:51], 0
global_load_dwordx4 a[172:175], v1, s[40:41] offset:2048 sc1
v_cvt_pk_bf16_f32 v198, v28, v29
v_mfma_f32_16x16x32_bf16 v[76:79], a[232:235], a[52:55], v[76:79]
ds_read_b128 a[100:103], v7 offset:35840
v_cvt_pk_bf16_f32 v199, v30, v31
v_mfma_f32_16x16x32_bf16 v[76:79], a[236:239], a[56:59], v[76:79]
ds_write_b128 v6, v[196:199] offset:1024
v_mfma_f32_16x16x32_bf16 v[76:79], a[240:243], a[60:63], v[76:79]
v_exp_f32_e64 v32, v32
v_mfma_f32_16x16x32_bf16 v[228:231], a[112:115], v[196:199], v[228:231]
v_exp_f32_e64 v33, v33
v_mfma_f32_16x16x32_bf16 v[144:147], v[208:211], a[116:119], v[144:147]
s_waitcnt vmcnt(10) lgkmcnt(2)
global_load_dwordx4 a[176:179], v1, s[40:41] offset:3072 sc1
v_cvt_pk_bf16_f32 v200, v32, v33
v_mfma_f32_16x16x32_bf16 v[144:147], a[64:67], a[120:123], v[144:147]
ds_read_b128 a[104:107], v8 offset:35840
global_load_dwordx4 a[180:183], v2, s[34:35] offset:0 sc1
v_mfma_f32_16x16x32_bf16 v[144:147], a[68:71], a[124:127], v[144:147]
v_exp_f32 v34, v34
v_mfma_f32_16x16x32_bf16 v[144:147], a[72:75], a[128:131], v[144:147]
v_exp_f32_e64 v35, v35
v_mfma_f32_16x16x32_bf16 v[152:155], v[212:215], a[116:119], v[152:155]
v_exp_f32_e64 v36, v36
v_mfma_f32_16x16x32_bf16 v[152:155], a[76:79], a[120:123], v[152:155]
ds_read_b128 a[108:111], v9 offset:35840
v_cvt_pk_bf16_f32 v201, v34, v35
v_mfma_f32_16x16x32_bf16 v[152:155], a[80:83], a[124:127], v[152:155]
v_exp_f32_e64 v37, v37
v_mfma_f32_16x16x32_bf16 v[152:155], a[84:87], a[128:131], v[152:155]
v_exp_f32_e64 v38, v38
v_mfma_f32_16x16x32_bf16 v[160:163], v[216:219], a[116:119], v[160:163]
global_load_dwordx4 a[184:187], v3, s[34:35] offset:0 sc1
v_cvt_pk_bf16_f32 v202, v36, v37
v_mfma_f32_16x16x32_bf16 v[160:163], a[88:91], a[120:123], v[160:163]
v_exp_f32_e64 v39, v39
v_mfma_f32_16x16x32_bf16 v[160:163], a[92:95], a[124:127], v[160:163]
v_exp_f32_e64 v40, v40
v_mfma_f32_16x16x32_bf16 v[160:163], a[96:99], a[128:131], v[160:163]
global_load_dwordx4 a[188:191], v4, s[34:35] offset:0 sc1
v_cvt_pk_bf16_f32 v203, v38, v39
v_mfma_f32_16x16x32_bf16 v[168:171], v[220:223], a[116:119], v[168:171]
s_waitcnt vmcnt(10) lgkmcnt(0)
global_load_dwordx4 a[192:195], v5, s[34:35] offset:0 sc1
buffer_load_dword v242, v244, s[8:11], s7 offen sc1
v_mfma_f32_16x16x32_bf16 v[168:171], a[100:103], a[120:123], v[168:171]
ds_write_b128 v6, v[200:203] offset:2048
v_mfma_f32_16x16x32_bf16 v[168:171], a[104:107], a[124:127], v[168:171]
v_exp_f32 v41, v41
v_mfma_f32_16x16x32_bf16 v[168:171], a[108:111], a[128:131], v[168:171]
v_exp_f32_e64 v42, v42
v_mfma_f32_16x16x32_bf16 v[232:235], a[112:115], v[200:203], v[232:235]
v_exp_f32_e64 v43, v43
v_mfma_f32_16x16x32_bf16 v[148:151], v[208:211], a[132:135], v[148:151]
v_exp_f32_e64 v44, v44
v_mfma_f32_16x16x32_bf16 v[148:151], a[64:67], a[136:139], v[148:151]
v_exp_f32_e64 v45, v45
v_mfma_f32_16x16x32_bf16 v[148:151], a[68:71], a[140:143], v[148:151]
v_exp_f32_e64 v46, v46
v_mfma_f32_16x16x32_bf16 v[148:151], a[72:75], a[144:147], v[148:151]
global_load_dwordx4 a[196:199], v2, s[34:35] offset:1024 sc1
v_cvt_pk_bf16_f32 v204, v40, v41
v_mfma_f32_16x16x32_bf16 v[156:159], v[212:215], a[132:135], v[156:159]
v_exp_f32_e64 v47, v47
v_mfma_f32_16x16x32_bf16 v[156:159], a[76:79], a[136:139], v[156:159]
v_exp_f32_e64 v48, v48
v_mfma_f32_16x16x32_bf16 v[156:159], a[80:83], a[140:143], v[156:159]
v_exp_f32_e64 v49, v49
v_mfma_f32_16x16x32_bf16 v[156:159], a[84:87], a[144:147], v[156:159]
global_load_dwordx4 a[200:203], v3, s[34:35] offset:1024 sc1
v_cvt_pk_bf16_f32 v205, v42, v43
v_mfma_f32_16x16x32_bf16 v[164:167], v[216:219], a[132:135], v[164:167]
v_exp_f32_e64 v50, v50
v_mfma_f32_16x16x32_bf16 v[164:167], a[88:91], a[136:139], v[164:167]
ds_read_b128 a[64:67], v7 offset:49152
v_cvt_pk_bf16_f32 v206, v44, v45
v_mfma_f32_16x16x32_bf16 v[164:167], a[92:95], a[140:143], v[164:167]
v_exp_f32_e64 v51, v51
v_mfma_f32_16x16x32_bf16 v[164:167], a[96:99], a[144:147], v[164:167]
global_load_dwordx4 a[204:207], v4, s[34:35] offset:1024 sc1
v_cvt_pk_bf16_f32 v207, v46, v47
v_mfma_f32_16x16x32_bf16 v[172:175], v[220:223], a[132:135], v[172:175]
ds_write_b128 v6, v[204:207] offset:3072
v_mfma_f32_16x16x32_bf16 v[172:175], a[100:103], a[136:139], v[172:175]
v_exp_f32_e64 v52, v52
v_mfma_f32_16x16x32_bf16 v[172:175], a[104:107], a[140:143], v[172:175]
global_load_dwordx4 a[208:211], v5, s[34:35] offset:1024 sc1
v_cvt_pk_bf16_f32 v208, v48, v49
v_mfma_f32_16x16x32_bf16 v[172:175], a[108:111], a[144:147], v[172:175]
ds_read_b128 a[68:71], v8 offset:49152
v_cvt_pk_bf16_f32 v209, v50, v51
v_mfma_f32_16x16x32_bf16 v[236:239], a[112:115], v[204:207], v[236:239]
v_exp_f32_e64 v53, v53
v_mfma_f32_16x16x32_bf16 v[80:83], a[148:151], a[0:3], 0
s_waitcnt vmcnt(11)
v_exp_f32 v54, v54
v_mfma_f32_16x16x32_bf16 v[80:83], a[152:155], a[4:7], v[80:83]
ds_read_b128 a[72:75], v9 offset:49152
v_cvt_pk_bf16_f32 v210, v52, v53
v_mfma_f32_16x16x32_bf16 v[80:83], a[156:159], a[8:11], v[80:83]
s_waitcnt lgkmcnt(2)
s_barrier
v_mfma_f32_16x16x32_bf16 v[80:83], a[160:163], a[12:15], v[80:83]
global_load_dwordx4 a[212:215], v1, s[42:43] offset:-4096 sc1
global_load_dwordx4 a[216:219], v1, s[42:43] offset:-3072 sc1
v_mfma_f32_16x16x32_bf16 v[88:91], a[148:151], a[16:19], 0
v_exp_f32_e64 v55, v55
v_mfma_f32_16x16x32_bf16 v[88:91], a[152:155], a[20:23], v[88:91]
ds_read_b128 a[76:79], v7 offset:50176
v_cvt_pk_bf16_f32 v211, v54, v55
v_mfma_f32_16x16x32_bf16 v[88:91], a[156:159], a[24:27], v[88:91]
ds_write_b128 v6, v[208:211] offset:16384
v_mfma_f32_16x16x32_bf16 v[88:91], a[160:163], a[28:31], v[88:91]
v_exp_f32_e64 v56, v56
v_mfma_f32_16x16x32_bf16 v[224:227], a[112:115], v[208:211], v[224:227]
v_exp_f32_e64 v57, v57
v_mfma_f32_16x16x32_bf16 v[96:99], a[148:151], a[32:35], 0
v_exp_f32_e64 v58, v58
v_mfma_f32_16x16x32_bf16 v[96:99], a[152:155], a[36:39], v[96:99]
ds_read_b128 a[80:83], v8 offset:50176
v_cvt_pk_bf16_f32 v212, v56, v57
v_mfma_f32_16x16x32_bf16 v[96:99], a[156:159], a[40:43], v[96:99]
global_load_dwordx4 a[220:223], v1, s[42:43] offset:-2048 sc1
ds_read_b128 a[84:87], v9 offset:50176
v_mfma_f32_16x16x32_bf16 v[96:99], a[160:163], a[44:47], v[96:99]
v_exp_f32_e64 v59, v59
v_mfma_f32_16x16x32_bf16 v[104:107], a[148:151], a[48:51], 0
v_exp_f32_e64 v60, v60
v_mfma_f32_16x16x32_bf16 v[104:107], a[152:155], a[52:55], v[104:107]
v_exp_f32_e64 v61, v61
v_mfma_f32_16x16x32_bf16 v[104:107], a[156:159], a[56:59], v[104:107]
global_load_dwordx4 a[224:227], v1, s[42:43] offset:-1024 sc1
v_cvt_pk_bf16_f32 v213, v58, v59
v_mfma_f32_16x16x32_bf16 v[104:107], a[160:163], a[60:63], v[104:107]
v_exp_f32_e64 v62, v62
v_mfma_f32_16x16x32_bf16 v[84:87], a[164:167], a[0:3], 0
v_exp_f32_e64 v63, v63
v_mfma_f32_16x16x32_bf16 v[84:87], a[168:171], a[4:7], v[84:87]
s_waitcnt vmcnt(11) lgkmcnt(0)
ds_read_b128 a[88:91], v7 offset:51200
v_cvt_pk_bf16_f32 v214, v60, v61
v_mfma_f32_16x16x32_bf16 v[84:87], a[172:175], a[8:11], v[84:87]
global_load_dwordx4 a[228:231], v1, s[42:43] offset:0 sc1
v_cvt_pk_bf16_f32 v215, v62, v63
v_mfma_f32_16x16x32_bf16 v[84:87], a[176:179], a[12:15], v[84:87]
ds_write_b128 v6, v[212:215] offset:17408
v_mfma_f32_16x16x32_bf16 v[228:231], a[112:115], v[212:215], v[228:231]
v_exp_f32 v64, v64
v_mfma_f32_16x16x32_bf16 v[92:95], a[164:167], a[16:19], 0
v_exp_f32_e64 v65, v65
v_mfma_f32_16x16x32_bf16 v[92:95], a[168:171], a[20:23], v[92:95]
global_load_dwordx4 a[232:235], v1, s[42:43] offset:1024 sc1
ds_read_b128 a[92:95], v8 offset:51200
v_mfma_f32_16x16x32_bf16 v[92:95], a[172:175], a[24:27], v[92:95]
v_exp_f32_e64 v66, v66
v_mfma_f32_16x16x32_bf16 v[92:95], a[176:179], a[28:31], v[92:95]
v_exp_f32_e64 v67, v67
v_mfma_f32_16x16x32_bf16 v[100:103], a[164:167], a[32:35], 0
v_exp_f32_e64 v68, v68
v_mfma_f32_16x16x32_bf16 v[100:103], a[168:171], a[36:39], v[100:103]
global_load_dwordx4 a[236:239], v1, s[42:43] offset:2048 sc1
ds_read_b128 a[96:99], v9 offset:51200
v_mfma_f32_16x16x32_bf16 v[100:103], a[172:175], a[40:43], v[100:103]
v_exp_f32_e64 v69, v69
v_mfma_f32_16x16x32_bf16 v[100:103], a[176:179], a[44:47], v[100:103]
v_exp_f32_e64 v70, v70
v_mfma_f32_16x16x32_bf16 v[108:111], a[164:167], a[48:51], 0
v_exp_f32_e64 v71, v71
v_mfma_f32_16x16x32_bf16 v[108:111], a[168:171], a[52:55], v[108:111]
global_load_dwordx4 a[240:243], v1, s[42:43] offset:3072 sc1
ds_read_b128 a[100:103], v7 offset:52224
v_mfma_f32_16x16x32_bf16 v[108:111], a[172:175], a[56:59], v[108:111]
s_waitcnt vmcnt(12)
v_cmp_ne_u32 vcc, s24, v242
v_cvt_pk_bf16_f32 v216, v64, v65
v_mfma_f32_16x16x32_bf16 v[108:111], a[176:179], a[60:63], v[108:111]
v_exp_f32_e64 v72, v72
v_mfma_f32_16x16x32_bf16 v[144:147], v[176:179], a[180:183], v[144:147]
s_cbranch_vccnz Lrvslow
Lrvback:
v_cvt_pk_bf16_f32 v217, v66, v67
v_mfma_f32_16x16x32_bf16 v[144:147], a[64:67], a[184:187], v[144:147]
global_load_dwordx4 a[116:119], v2, s[36:37] offset:0 sc1
ds_read_b128 a[104:107], v8 offset:52224
v_mfma_f32_16x16x32_bf16 v[144:147], a[68:71], a[188:191], v[144:147]
v_exp_f32 v73, v73
v_mfma_f32_16x16x32_bf16 v[144:147], a[72:75], a[192:195], v[144:147]
v_exp_f32_e64 v74, v74
v_mfma_f32_16x16x32_bf16 v[152:155], v[180:183], a[180:183], v[152:155]
v_exp_f32_e64 v75, v75
v_mfma_f32_16x16x32_bf16 v[152:155], a[76:79], a[184:187], v[152:155]
global_load_dwordx4 a[120:123], v3, s[36:37] offset:0 sc1
ds_read_b128 a[108:111], v9 offset:52224
v_mfma_f32_16x16x32_bf16 v[152:155], a[80:83], a[188:191], v[152:155]
v_exp_f32_e64 v76, v76
v_mfma_f32_16x16x32_bf16 v[152:155], a[84:87], a[192:195], v[152:155]
v_exp_f32_e64 v77, v77
v_mfma_f32_16x16x32_bf16 v[160:163], v[184:187], a[180:183], v[160:163]
s_waitcnt vmcnt(10) lgkmcnt(1)
v_cvt_pk_bf16_f32 v218, v68, v69
v_cvt_pk_bf16_f32 v219, v70, v71
v_mfma_f32_16x16x32_bf16 v[160:163], a[88:91], a[184:187], v[160:163]
ds_write_b128 v6, v[216:219] offset:18432
v_mfma_f32_16x16x32_bf16 v[160:163], a[92:95], a[188:191], v[160:163]
global_load_dwordx4 a[124:127], v4, s[36:37] offset:0 sc1
v_cvt_pk_bf16_f32 v220, v72, v73
v_mfma_f32_16x16x32_bf16 v[160:163], a[96:99], a[192:195], v[160:163]
v_exp_f32 v78, v78
v_mfma_f32_16x16x32_bf16 v[232:235], a[112:115], v[216:219], v[232:235]
v_exp_f32_e64 v79, v79
v_mfma_f32_16x16x32_bf16 v[168:171], v[188:191], a[180:183], v[168:171]
global_load_dwordx4 a[128:131], v5, s[36:37] offset:0 sc1
v_cvt_pk_bf16_f32 v221, v74, v75
v_mfma_f32_16x16x32_bf16 v[168:171], a[100:103], a[184:187], v[168:171]
v_exp_f32_e64 v80, v80
v_mfma_f32_16x16x32_bf16 v[168:171], a[104:107], a[188:191], v[168:171]
s_waitcnt vmcnt(10) lgkmcnt(1)
v_exp_f32 v81, v81
v_mfma_f32_16x16x32_bf16 v[168:171], a[108:111], a[192:195], v[168:171]
v_exp_f32_e64 v82, v82
v_mfma_f32_16x16x32_bf16 v[148:151], v[176:179], a[196:199], v[148:151]
global_load_dwordx4 a[132:135], v2, s[36:37] offset:1024 sc1
v_cvt_pk_bf16_f32 v222, v76, v77
v_mfma_f32_16x16x32_bf16 v[148:151], a[64:67], a[200:203], v[148:151]
v_exp_f32_e64 v83, v83
v_mfma_f32_16x16x32_bf16 v[148:151], a[68:71], a[204:207], v[148:151]
v_exp_f32_e64 v84, v84
v_mfma_f32_16x16x32_bf16 v[148:151], a[72:75], a[208:211], v[148:151]
v_exp_f32_e64 v85, v85
v_mfma_f32_16x16x32_bf16 v[156:159], v[180:183], a[196:199], v[156:159]
global_load_dwordx4 a[136:139], v3, s[36:37] offset:1024 sc1
v_cvt_pk_bf16_f32 v223, v78, v79
v_mfma_f32_16x16x32_bf16 v[156:159], a[76:79], a[200:203], v[156:159]
ds_write_b128 v6, v[220:223] offset:19456
v_mfma_f32_16x16x32_bf16 v[156:159], a[80:83], a[204:207], v[156:159]
v_exp_f32_e64 v86, v86
v_mfma_f32_16x16x32_bf16 v[156:159], a[84:87], a[208:211], v[156:159]
v_exp_f32_e64 v87, v87
v_mfma_f32_16x16x32_bf16 v[236:239], a[112:115], v[220:223], v[236:239]
v_exp_f32_e64 v88, v88
v_mfma_f32_16x16x32_bf16 v[164:167], v[184:187], a[196:199], v[164:167]
global_load_dwordx4 a[140:143], v4, s[36:37] offset:1024 sc1
v_cvt_pk_bf16_f32 v176, v80, v81
v_mfma_f32_16x16x32_bf16 v[164:167], a[88:91], a[200:203], v[164:167]
ds_read_b128 a[64:67], v7 offset:0
v_cvt_pk_bf16_f32 v177, v82, v83
v_mfma_f32_16x16x32_bf16 v[164:167], a[92:95], a[204:207], v[164:167]
ds_read_b128 a[68:71], v8 offset:0
v_cvt_pk_bf16_f32 v178, v84, v85
v_mfma_f32_16x16x32_bf16 v[164:167], a[96:99], a[208:211], v[164:167]
s_waitcnt lgkmcnt(2)
s_barrier
v_mfma_f32_16x16x32_bf16 v[172:175], v[188:191], a[196:199], v[172:175]
global_load_dwordx4 a[144:147], v5, s[36:37] offset:1024 sc1
ds_read_b128 a[72:75], v9 offset:0
v_mfma_f32_16x16x32_bf16 v[172:175], a[100:103], a[200:203], v[172:175]
ds_read_b128 a[76:79], v7 offset:1024
v_cvt_pk_bf16_f32 v179, v86, v87
v_mfma_f32_16x16x32_bf16 v[172:175], a[104:107], a[204:207], v[172:175]
ds_write_b128 v6, v[176:179] offset:32768
v_mfma_f32_16x16x32_bf16 v[172:175], a[108:111], a[208:211], v[172:175]
v_exp_f32_e64 v89, v89
v_mfma_f32_16x16x32_bf16 v[224:227], a[112:115], v[176:179], v[224:227]
v_exp_f32_e64 v90, v90
v_mfma_f32_16x16x32_bf16 v[112:115], a[212:215], a[0:3], 0
global_load_dwordx4 a[148:151], v2, s[38:39] offset:0 sc1
ds_read_b128 a[80:83], v8 offset:1024
v_mfma_f32_16x16x32_bf16 v[112:115], a[216:219], a[4:7], v[112:115]
s_waitcnt vmcnt(10)
ds_read_b128 a[84:87], v9 offset:1024
ds_read_b128 a[88:91], v7 offset:2048
v_mfma_f32_16x16x32_bf16 v[112:115], a[220:223], a[8:11], v[112:115]
v_exp_f32 v91, v91
v_mfma_f32_16x16x32_bf16 v[112:115], a[224:227], a[12:15], v[112:115]
global_load_dwordx4 a[152:155], v3, s[38:39] offset:0 sc1
v_cvt_pk_bf16_f32 v180, v88, v89
v_mfma_f32_16x16x32_bf16 v[120:123], a[212:215], a[16:19], 0
v_exp_f32_e64 v92, v92
v_mfma_f32_16x16x32_bf16 v[120:123], a[216:219], a[20:23], v[120:123]
ds_read_b128 a[92:95], v8 offset:2048
v_cvt_pk_bf16_f32 v181, v90, v91
v_mfma_f32_16x16x32_bf16 v[120:123], a[220:223], a[24:27], v[120:123]
v_exp_f32_e64 v93, v93
v_mfma_f32_16x16x32_bf16 v[120:123], a[224:227], a[28:31], v[120:123]
global_load_dwordx4 a[156:159], v4, s[38:39] offset:0 sc1
v_cvt_pk_bf16_f32 v182, v92, v93
v_mfma_f32_16x16x32_bf16 v[128:131], a[212:215], a[32:35], 0
v_exp_f32_e64 v94, v94
v_mfma_f32_16x16x32_bf16 v[128:131], a[216:219], a[36:39], v[128:131]
ds_read_b128 a[96:99], v9 offset:2048
global_load_dwordx4 a[160:163], v5, s[38:39] offset:0 sc1
v_mfma_f32_16x16x32_bf16 v[128:131], a[220:223], a[40:43], v[128:131]
v_exp_f32_e64 v95, v95
v_mfma_f32_16x16x32_bf16 v[128:131], a[224:227], a[44:47], v[128:131]
v_exp_f32_e64 v96, v96
v_mfma_f32_16x16x32_bf16 v[136:139], a[212:215], a[48:51], 0
v_exp_f32_e64 v97, v97
v_mfma_f32_16x16x32_bf16 v[136:139], a[216:219], a[52:55], v[136:139]
ds_read_b128 a[100:103], v7 offset:3072
v_cvt_pk_bf16_f32 v183, v94, v95
v_mfma_f32_16x16x32_bf16 v[136:139], a[220:223], a[56:59], v[136:139]
ds_write_b128 v6, v[180:183] offset:33792
v_mfma_f32_16x16x32_bf16 v[136:139], a[224:227], a[60:63], v[136:139]
global_load_dwordx4 a[164:167], v2, s[38:39] offset:1024 sc1
v_cvt_pk_bf16_f32 v184, v96, v97
v_mfma_f32_16x16x32_bf16 v[228:231], a[112:115], v[180:183], v[228:231]
v_exp_f32_e64 v98, v98
v_mfma_f32_16x16x32_bf16 v[116:119], a[228:231], a[0:3], 0
v_exp_f32_e64 v99, v99
v_mfma_f32_16x16x32_bf16 v[116:119], a[232:235], a[4:7], v[116:119]
ds_read_b128 a[104:107], v8 offset:3072
v_cvt_pk_bf16_f32 v185, v98, v99
v_mfma_f32_16x16x32_bf16 v[116:119], a[236:239], a[8:11], v[116:119]
s_waitcnt vmcnt(10) lgkmcnt(4)
v_exp_f32 v100, v100
v_mfma_f32_16x16x32_bf16 v[116:119], a[240:243], a[12:15], v[116:119]
global_load_dwordx4 a[168:171], v3, s[38:39] offset:1024 sc1
global_load_dwordx4 a[172:175], v4, s[38:39] offset:1024 sc1
v_mfma_f32_16x16x32_bf16 v[124:127], a[228:231], a[16:19], 0
v_exp_f32_e64 v101, v101
v_mfma_f32_16x16x32_bf16 v[124:127], a[232:235], a[20:23], v[124:127]
ds_read_b128 a[108:111], v9 offset:3072
v_cvt_pk_bf16_f32 v186, v100, v101
v_mfma_f32_16x16x32_bf16 v[124:127], a[236:239], a[24:27], v[124:127]
v_exp_f32_e64 v102, v102
v_mfma_f32_16x16x32_bf16 v[124:127], a[240:243], a[28:31], v[124:127]
v_exp_f32_e64 v103, v103
v_mfma_f32_16x16x32_bf16 v[132:135], a[228:231], a[32:35], 0
v_exp_f32_e64 v104, v104
v_mfma_f32_16x16x32_bf16 v[132:135], a[232:235], a[36:39], v[132:135]
v_exp_f32_e64 v105, v105
v_mfma_f32_16x16x32_bf16 v[132:135], a[236:239], a[40:43], v[132:135]
Ltouch2:
s_cbranch_execz Lret
s_nop 0
global_load_dwordx4 a[176:179], v5, s[38:39] offset:1024 sc1
v_cvt_pk_bf16_f32 v187, v102, v103
v_mfma_f32_16x16x32_bf16 v[132:135], a[240:243], a[44:47], v[132:135]
ds_write_b128 v6, v[184:187] offset:34816
v_mfma_f32_16x16x32_bf16 v[232:235], a[112:115], v[184:187], v[232:235]
v_exp_f32_e64 v106, v106
v_mfma_f32_16x16x32_bf16 v[140:143], a[228:231], a[48:51], 0
v_exp_f32_e64 v107, v107
v_mfma_f32_16x16x32_bf16 v[140:143], a[232:235], a[52:55], v[140:143]
v_exp_f32_e64 v108, v108
v_mfma_f32_16x16x32_bf16 v[140:143], a[236:239], a[56:59], v[140:143]
global_load_dwordx4 a[180:183], v2, s[40:41] offset:0 sc1
v_cvt_pk_bf16_f32 v188, v104, v105
v_mfma_f32_16x16x32_bf16 v[140:143], a[240:243], a[60:63], v[140:143]
v_exp_f32_e64 v109, v109
v_mfma_f32_16x16x32_bf16 v[144:147], v[192:195], a[116:119], v[144:147]
v_exp_f32_e64 v110, v110
v_mfma_f32_16x16x32_bf16 v[144:147], a[64:67], a[120:123], v[144:147]
v_exp_f32_e64 v111, v111
v_mfma_f32_16x16x32_bf16 v[144:147], a[68:71], a[124:127], v[144:147]
s_waitcnt vmcnt(10) lgkmcnt(1)
global_load_dwordx4 a[184:187], v3, s[40:41] offset:0 sc1
v_cvt_pk_bf16_f32 v189, v106, v107
v_mfma_f32_16x16x32_bf16 v[144:147], a[72:75], a[128:131], v[144:147]
v_exp_f32 v112, v112
v_mfma_f32_16x16x32_bf16 v[152:155], v[196:199], a[116:119], v[152:155]
v_exp_f32_e64 v113, v113
v_mfma_f32_16x16x32_bf16 v[152:155], a[76:79], a[120:123], v[152:155]
v_exp_f32_e64 v114, v114
v_mfma_f32_16x16x32_bf16 v[152:155], a[80:83], a[124:127], v[152:155]
global_load_dwordx4 a[188:191], v4, s[40:41] offset:0 sc1
v_cvt_pk_bf16_f32 v190, v108, v109
v_mfma_f32_16x16x32_bf16 v[152:155], a[84:87], a[128:131], v[152:155]
v_exp_f32_e64 v115, v115
v_mfma_f32_16x16x32_bf16 v[160:163], v[200:203], a[116:119], v[160:163]
v_exp_f32_e64 v116, v116
v_mfma_f32_16x16x32_bf16 v[160:163], a[88:91], a[120:123], v[160:163]
v_exp_f32_e64 v117, v117
v_mfma_f32_16x16x32_bf16 v[160:163], a[92:95], a[124:127], v[160:163]
global_load_dwordx4 a[192:195], v5, s[40:41] offset:0 sc1
v_cvt_pk_bf16_f32 v191, v110, v111
v_mfma_f32_16x16x32_bf16 v[160:163], a[96:99], a[128:131], v[160:163]
ds_write_b128 v6, v[188:191] offset:35840
v_mfma_f32_16x16x32_bf16 v[236:239], a[112:115], v[188:191], v[236:239]
v_exp_f32_e64 v118, v118
v_mfma_f32_16x16x32_bf16 v[168:171], v[204:207], a[116:119], v[168:171]
v_exp_f32_e64 v119, v119
v_mfma_f32_16x16x32_bf16 v[168:171], a[100:103], a[120:123], v[168:171]
global_load_dwordx4 a[196:199], v2, s[40:41] offset:1024 sc1
v_mfma_f32_16x16x32_bf16 v[168:171], a[104:107], a[124:127], v[168:171]
v_exp_f32_e64 v120, v120
v_mfma_f32_16x16x32_bf16 v[168:171], a[108:111], a[128:131], v[168:171]
s_waitcnt lgkmcnt(0)
s_barrier
v_mfma_f32_16x16x32_bf16 v[148:151], v[192:195], a[132:135], v[148:151]
v_exp_f32_e64 v121, v121
v_mfma_f32_16x16x32_bf16 v[148:151], a[64:67], a[136:139], v[148:151]
global_load_dwordx4 a[200:203], v3, s[40:41] offset:1024 sc1
ds_read_b128 a[64:67], v7 offset:16384
v_mfma_f32_16x16x32_bf16 v[148:151], a[68:71], a[140:143], v[148:151]
s_waitcnt vmcnt(10)
ds_read_b128 a[68:71], v8 offset:16384
v_cvt_pk_bf16_f32 v192, v112, v113
v_mfma_f32_16x16x32_bf16 v[148:151], a[72:75], a[144:147], v[148:151]
ds_read_b128 a[72:75], v9 offset:16384
v_cvt_pk_bf16_f32 v193, v114, v115
v_mfma_f32_16x16x32_bf16 v[156:159], v[196:199], a[132:135], v[156:159]
v_exp_f32 v122, v122
v_mfma_f32_16x16x32_bf16 v[156:159], a[76:79], a[136:139], v[156:159]
global_load_dwordx4 a[204:207], v4, s[40:41] offset:1024 sc1
ds_read_b128 a[76:79], v7 offset:17408
v_mfma_f32_16x16x32_bf16 v[156:159], a[80:83], a[140:143], v[156:159]
ds_read_b128 a[80:83], v8 offset:17408
v_cvt_pk_bf16_f32 v194, v116, v117
v_mfma_f32_16x16x32_bf16 v[156:159], a[84:87], a[144:147], v[156:159]
ds_read_b128 a[84:87], v9 offset:17408
v_cvt_pk_bf16_f32 v195, v118, v119
v_mfma_f32_16x16x32_bf16 v[164:167], v[200:203], a[132:135], v[164:167]
ds_write_b128 v6, v[192:195] offset:49152
v_mfma_f32_16x16x32_bf16 v[164:167], a[88:91], a[136:139], v[164:167]
global_load_dwordx4 a[208:211], v5, s[40:41] offset:1024 sc1
v_cvt_pk_bf16_f32 v196, v120, v121
v_mfma_f32_16x16x32_bf16 v[164:167], a[92:95], a[140:143], v[164:167]
v_exp_f32_e64 v123, v123
v_mfma_f32_16x16x32_bf16 v[164:167], a[96:99], a[144:147], v[164:167]
ds_read_b128 a[88:91], v7 offset:18432
ds_read_b128 a[92:95], v8 offset:18432
v_mfma_f32_16x16x32_bf16 v[224:227], a[112:115], v[192:195], v[224:227]
ds_read_b128 a[96:99], v9 offset:18432
v_cvt_pk_bf16_f32 v197, v122, v123
v_mfma_f32_16x16x32_bf16 v[172:175], v[204:207], a[132:135], v[172:175]
v_exp_f32_e64 v124, v124
v_mfma_f32_16x16x32_bf16 v[172:175], a[100:103], a[136:139], v[172:175]
global_load_dwordx4 a[212:215], v2, s[42:43] offset:0 sc1
ds_read_b128 a[100:103], v7 offset:19456
v_mfma_f32_16x16x32_bf16 v[172:175], a[104:107], a[140:143], v[172:175]
ds_read_b128 a[104:107], v8 offset:19456
global_load_dwordx4 a[216:219], v3, s[42:43] offset:0 sc1
v_mfma_f32_16x16x32_bf16 v[172:175], a[108:111], a[144:147], v[172:175]
v_exp_f32_e64 v125, v125
v_mfma_f32_16x16x32_bf16 v[144:147], v[208:211], a[148:151], v[144:147]
s_waitcnt vmcnt(11) lgkmcnt(6)
ds_read_b128 a[108:111], v9 offset:19456
v_cvt_pk_bf16_f32 v198, v124, v125
v_mfma_f32_16x16x32_bf16 v[144:147], a[64:67], a[152:155], v[144:147]
v_exp_f32 v126, v126
v_mfma_f32_16x16x32_bf16 v[144:147], a[68:71], a[156:159], v[144:147]
v_exp_f32_e64 v127, v127
v_mfma_f32_16x16x32_bf16 v[144:147], a[72:75], a[160:163], v[144:147]
v_exp_f32_e64 v128, v128
v_mfma_f32_16x16x32_bf16 v[152:155], v[212:215], a[148:151], v[152:155]
global_load_dwordx4 a[220:223], v4, s[42:43] offset:0 sc1
v_cvt_pk_bf16_f32 v199, v126, v127
v_mfma_f32_16x16x32_bf16 v[152:155], a[76:79], a[152:155], v[152:155]
ds_write_b128 v6, v[196:199] offset:50176
v_mfma_f32_16x16x32_bf16 v[152:155], a[80:83], a[156:159], v[152:155]
v_exp_f32_e64 v129, v129
v_mfma_f32_16x16x32_bf16 v[152:155], a[84:87], a[160:163], v[152:155]
v_exp_f32_e64 v130, v130
v_mfma_f32_16x16x32_bf16 v[228:231], a[112:115], v[196:199], v[228:231]
v_exp_f32_e64 v131, v131
v_mfma_f32_16x16x32_bf16 v[160:163], v[216:219], a[148:151], v[160:163]
s_waitcnt vmcnt(10) lgkmcnt(1)
global_load_dwordx4 a[224:227], v5, s[42:43] offset:0 sc1
v_cvt_pk_bf16_f32 v200, v128, v129
v_mfma_f32_16x16x32_bf16 v[160:163], a[88:91], a[152:155], v[160:163]
v_permlane32_swap_b32 v224, v228
v_cvt_pk_bf16_f32 v201, v130, v131
v_mfma_f32_16x16x32_bf16 v[160:163], a[92:95], a[156:159], v[160:163]
ds_write_b32 v10, v224 offset:0
v_mfma_f32_16x16x32_bf16 v[160:163], a[96:99], a[160:163], v[160:163]
v_exp_f32_e64 v132, v132
v_mfma_f32_16x16x32_bf16 v[168:171], v[220:223], a[148:151], v[168:171]
v_exp_f32_e64 v133, v133
v_mfma_f32_16x16x32_bf16 v[168:171], a[100:103], a[152:155], v[168:171]
global_load_dwordx4 a[228:231], v2, s[42:43] offset:1024 sc1
v_cvt_pk_bf16_f32 v202, v132, v133
v_mfma_f32_16x16x32_bf16 v[168:171], a[104:107], a[156:159], v[168:171]
v_exp_f32_e64 v134, v134
v_mfma_f32_16x16x32_bf16 v[168:171], a[108:111], a[160:163], v[168:171]
s_waitcnt lgkmcnt(0)
s_barrier
v_mfma_f32_16x16x32_bf16 v[148:151], v[208:211], a[164:167], v[148:151]
v_exp_f32_e64 v135, v135
v_mfma_f32_16x16x32_bf16 v[148:151], a[64:67], a[168:171], v[148:151]
global_load_dwordx4 a[232:235], v3, s[42:43] offset:1024 sc1
ds_read_b128 a[64:67], v7 offset:32768
v_mfma_f32_16x16x32_bf16 v[148:151], a[68:71], a[172:175], v[148:151]
ds_read_b128 a[68:71], v8 offset:32768
v_cvt_pk_bf16_f32 v203, v134, v135
v_mfma_f32_16x16x32_bf16 v[148:151], a[72:75], a[176:179], v[148:151]
ds_write_b128 v6, v[200:203] offset:51200
v_mfma_f32_16x16x32_bf16 v[232:235], a[112:115], v[200:203], v[232:235]
v_exp_f32_e64 v136, v136
v_mfma_f32_16x16x32_bf16 v[156:159], v[212:215], a[164:167], v[156:159]
global_load_dwordx4 a[236:239], v4, s[42:43] offset:1024 sc1
ds_read_b128 v[240:243], v11
v_mfma_f32_16x16x32_bf16 v[156:159], a[76:79], a[168:171], v[156:159]
ds_read_b128 a[72:75], v9 offset:32768
ds_read_b128 a[76:79], v7 offset:33792
v_mfma_f32_16x16x32_bf16 v[156:159], a[80:83], a[172:175], v[156:159]
ds_read_b128 a[80:83], v8 offset:33792
global_load_dwordx4 a[240:243], v5, s[42:43] offset:1024 sc1
v_mfma_f32_16x16x32_bf16 v[156:159], a[84:87], a[176:179], v[156:159]
v_exp_f32_e64 v137, v137
v_mfma_f32_16x16x32_bf16 v[164:167], v[216:219], a[164:167], v[164:167]
ds_read_b128 a[84:87], v9 offset:33792
v_cvt_pk_bf16_f32 v204, v136, v137
v_mfma_f32_16x16x32_bf16 v[164:167], a[88:91], a[168:171], v[164:167]
v_exp_f32_e64 v138, v138
v_mfma_f32_16x16x32_bf16 v[164:167], a[92:95], a[172:175], v[164:167]
v_exp_f32_e64 v139, v139
v_mfma_f32_16x16x32_bf16 v[164:167], a[96:99], a[176:179], v[164:167]
s_waitcnt lgkmcnt(4)
v_add_f32 v240, v240, v241
v_add_f32_e64 v242, v242, v243
v_mfma_f32_16x16x32_bf16 v[172:175], v[220:223], a[164:167], v[172:175]
ds_read_b128 a[88:91], v7 offset:49152
v_add_f32_e64 v250, v240, v242
v_mfma_f32_16x16x32_bf16 v[172:175], a[100:103], a[168:171], v[172:175]
s_cmp_eq_u32 s60, s26
ds_read_b128 a[92:95], v8 offset:49152
ds_read_b128 a[96:99], v9 offset:49152
v_mfma_f32_16x16x32_bf16 v[172:175], a[104:107], a[172:175], v[172:175]
s_cbranch_scc0 Lfarl
buffer_store_dwordx2 v[250:251], v247, s[8:11], s33 offen
Lfarlback:
v_mfma_f32_16x16x32_bf16 v[172:175], a[108:111], a[176:179], v[172:175]
ds_read_b128 a[100:103], v7 offset:50176
buffer_load_dword v246, v252, s[12:15], s57 offen sc1
v_mfma_f32_16x16x32_bf16 v[144:147], v[176:179], a[180:183], v[144:147]
s_waitcnt vmcnt(10) lgkmcnt(4)
ds_read_b128 a[104:107], v8 offset:50176
ds_read_b128 a[108:111], v9 offset:50176
v_mfma_f32_16x16x32_bf16 v[144:147], a[64:67], a[184:187], v[144:147]
v_exp_f32 v140, v140
v_mfma_f32_16x16x32_bf16 v[144:147], a[68:71], a[188:191], v[144:147]
v_exp_f32_e64 v141, v141
v_mfma_f32_16x16x32_bf16 v[144:147], a[72:75], a[192:195], v[144:147]
v_exp_f32_e64 v142, v142
v_mfma_f32_16x16x32_bf16 v[152:155], v[180:183], a[180:183], v[152:155]
v_exp_f32_e64 v143, v143
v_mfma_f32_16x16x32_bf16 v[152:155], a[76:79], a[184:187], v[152:155]
v_cvt_pk_bf16_f32 v205, v138, v139
v_cvt_pk_bf16_f32 v206, v140, v141
v_mfma_f32_16x16x32_bf16 v[152:155], a[80:83], a[188:191], v[152:155]
v_cvt_pk_bf16_f32 v207, v142, v143
v_mfma_f32_16x16x32_bf16 v[152:155], a[84:87], a[192:195], v[152:155]
ds_write_b128 v6, v[204:207] offset:52224
v_mfma_f32_16x16x32_bf16 v[236:239], a[112:115], v[204:207], v[236:239]
v_mfma_f32_16x16x32_bf16 v[148:151], v[176:179], a[196:199], v[148:151]
v_mfma_f32_16x16x32_bf16 v[148:151], a[64:67], a[200:203], v[148:151]
ds_read_b128 a[64:67], v7 offset:34816
v_permlane32_swap_b32 v232, v236
v_mfma_f32_16x16x32_bf16 v[148:151], a[68:71], a[204:207], v[148:151]
ds_write_b32 v10, v232 offset:1024
v_mfma_f32_16x16x32_bf16 v[148:151], a[72:75], a[208:211], v[148:151]
ds_read_b128 a[68:71], v8 offset:34816
ds_read_b128 a[72:75], v9 offset:34816
v_mfma_f32_16x16x32_bf16 v[156:159], v[180:183], a[196:199], v[156:159]
v_mfma_f32_16x16x32_bf16 v[156:159], a[76:79], a[200:203], v[156:159]
ds_read_b128 a[76:79], v7 offset:35840
v_mfma_f32_16x16x32_bf16 v[156:159], a[80:83], a[204:207], v[156:159]
ds_read_b128 a[80:83], v8 offset:35840
v_mfma_f32_16x16x32_bf16 v[156:159], a[84:87], a[208:211], v[156:159]
s_waitcnt vmcnt(6) lgkmcnt(7)
ds_read_b128 a[84:87], v9 offset:35840
v_mfma_f32_16x16x32_bf16 v[144:147], v[192:195], a[212:215], v[144:147]
v_mfma_f32_16x16x32_bf16 v[144:147], a[88:91], a[216:219], v[144:147]
v_mfma_f32_16x16x32_bf16 v[144:147], a[92:95], a[220:223], v[144:147]
v_mfma_f32_16x16x32_bf16 v[144:147], a[96:99], a[224:227], v[144:147]
v_mfma_f32_16x16x32_bf16 v[152:155], v[196:199], a[212:215], v[152:155]
v_mfma_f32_16x16x32_bf16 v[152:155], a[100:103], a[216:219], v[152:155]
v_mfma_f32_16x16x32_bf16 v[152:155], a[104:107], a[220:223], v[152:155]
v_mfma_f32_16x16x32_bf16 v[152:155], a[108:111], a[224:227], v[152:155]
s_waitcnt vmcnt(5) lgkmcnt(0)
v_mfma_f32_16x16x32_bf16 v[148:151], v[192:195], a[228:231], v[148:151]
s_waitcnt vmcnt(4)
buffer_load_dwordx2 v[248:249], v247, s[8:11], s52 offen sc1
v_mfma_f32_16x16x32_bf16 v[148:151], a[88:91], a[232:235], v[148:151]
s_waitcnt vmcnt(4)
v_mfma_f32_16x16x32_bf16 v[148:151], a[92:95], a[236:239], v[148:151]
s_waitcnt vmcnt(3)
v_mfma_f32_16x16x32_bf16 v[148:151], a[96:99], a[240:243], v[148:151]
v_mfma_f32_16x16x32_bf16 v[156:159], v[196:199], a[228:231], v[156:159]
v_mfma_f32_16x16x32_bf16 v[156:159], a[100:103], a[232:235], v[156:159]
v_cvt_pk_bf16_f32 v16, v144, v148
v_cvt_pk_bf16_f32 v17, v145, v149
v_cvt_pk_bf16_f32 v18, v146, v150
v_mfma_f32_16x16x32_bf16 v[156:159], a[104:107], a[236:239], v[156:159]
v_cvt_pk_bf16_f32 v19, v147, v151
v_min_u32 v16, -2, v16
v_min_u32 v17, -2, v17
v_mfma_f32_16x16x32_bf16 v[156:159], a[108:111], a[240:243], v[156:159]
v_min_u32_e64 v18, -2, v18
v_min_u32 v19, -2, v19
s_cmp_eq_u32 s60, s26
v_mfma_f32_16x16x32_bf16 v[160:163], v[184:187], a[180:183], v[160:163]
s_cbranch_scc0 Lfarx
buffer_store_dwordx4 v[16:19], v14, s[12:15], s61 offen
Lfarxback:
v_mfma_f32_16x16x32_bf16 v[160:163], a[64:67], a[184:187], v[160:163]
v_cvt_pk_bf16_f32 v20, v152, v156
v_cvt_pk_bf16_f32 v21, v153, v157
v_cvt_pk_bf16_f32 v22, v154, v158
v_cvt_pk_bf16_f32 v23, v155, v159
v_min_u32 v20, -2, v20
v_min_u32 v21, -2, v21
v_min_u32 v22, -2, v22
v_min_u32 v23, -2, v23
s_cbranch_scc0 Lfary
buffer_store_dwordx4 v[20:23], v15, s[12:15], s61 offen
Lfaryback:
v_mfma_f32_16x16x32_bf16 v[160:163], a[68:71], a[188:191], v[160:163]
v_mfma_f32_16x16x32_bf16 v[160:163], a[72:75], a[192:195], v[160:163]
s_barrier
v_mfma_f32_16x16x32_bf16 v[168:171], v[188:191], a[180:183], v[168:171]
ds_read_b128 a[88:91], v7 offset:51200
ds_read_b128 a[92:95], v8 offset:51200
v_mfma_f32_16x16x32_bf16 v[168:171], a[76:79], a[184:187], v[168:171]
ds_read_b128 a[96:99], v9 offset:51200
ds_read_b128 a[100:103], v7 offset:52224
v_mfma_f32_16x16x32_bf16 v[168:171], a[80:83], a[188:191], v[168:171]
ds_read_b128 a[104:107], v8 offset:52224
ds_read_b128 a[108:111], v9 offset:52224
v_mfma_f32_16x16x32_bf16 v[168:171], a[84:87], a[192:195], v[168:171]
v_mfma_f32_16x16x32_bf16 v[164:167], v[184:187], a[196:199], v[164:167]
v_mfma_f32_16x16x32_bf16 v[164:167], a[64:67], a[200:203], v[164:167]
v_mfma_f32_16x16x32_bf16 v[164:167], a[68:71], a[204:207], v[164:167]
ds_read_b128 v[240:243], v11 offset:1024
v_mfma_f32_16x16x32_bf16 v[164:167], a[72:75], a[208:211], v[164:167]
v_mfma_f32_16x16x32_bf16 v[172:175], v[188:191], a[196:199], v[172:175]
s_lshl_b32 s45, s28, 8
v_mfma_f32_16x16x32_bf16 v[172:175], a[76:79], a[200:203], v[172:175]
s_waitcnt vmcnt(2)
v_cmp_ne_u32 vcc, s24, v249
v_lshl_add_u32 v252, v0, 2, s45
v_and_or_b32 v253, v0, 48, s45
v_mfma_f32_16x16x32_bf16 v[172:175], a[80:83], a[204:207], v[172:175]
v_mfma_f32_16x16x32_bf16 v[172:175], a[84:87], a[208:211], v[172:175]
s_cbranch_vccnz Lrlslow
Lrlback:
v_mfma_f32_16x16x32_bf16 v[160:163], v[200:203], a[212:215], v[160:163]
s_waitcnt lgkmcnt(1)
buffer_load_dwordx4 v[32:35], v14, s[12:15], s57 offen sc1
v_mfma_f32_16x16x32_bf16 v[160:163], a[88:91], a[216:219], v[160:163]
buffer_load_dwordx4 v[36:39], v15, s[12:15], s57 offen sc1
v_mfma_f32_16x16x32_bf16 v[160:163], a[92:95], a[220:223], v[160:163]
s_waitcnt lgkmcnt(0)
v_add_f32 v240, v240, v241
v_add_f32_e64 v242, v242, v243
v_mfma_f32_16x16x32_bf16 v[160:163], a[96:99], a[224:227], v[160:163]
v_add_f32_e64 v240, v240, v242
v_mfma_f32_16x16x32_bf16 v[168:171], v[204:207], a[212:215], v[168:171]
v_add_f32_e64 v245, v240, v248
v_mfma_f32_16x16x32_bf16 v[168:171], a[100:103], a[216:219], v[168:171]
v_rcp_f32_e64 v246, v245
v_mfma_f32_16x16x32_bf16 v[168:171], a[104:107], a[220:223], v[168:171]
ds_write_b32 v252, v246 offset:10240
v_mfma_f32_16x16x32_bf16 v[168:171], a[108:111], a[224:227], v[168:171]
ds_read_b128 v[64:67], v253 offset:10240
ds_read_b128 v[68:71], v253 offset:10368
v_mfma_f32_16x16x32_bf16 v[164:167], v[200:203], a[228:231], v[164:167]
s_mov_b32 s45, 0x23000000
v_subrev_u32 v245, 0x30800000, v245
v_cmp_le_u32 s[4:5], s45, v245
v_mfma_f32_16x16x32_bf16 v[164:167], a[88:91], a[232:235], v[164:167]
v_mfma_f32_16x16x32_bf16 v[164:167], a[92:95], a[236:239], v[164:167]
v_mfma_f32_16x16x32_bf16 v[164:167], a[96:99], a[240:243], v[164:167]
v_mfma_f32_16x16x32_bf16 v[172:175], v[204:207], a[228:231], v[172:175]
v_mfma_f32_16x16x32_bf16 v[172:175], a[100:103], a[232:235], v[172:175]
v_mfma_f32_16x16x32_bf16 v[172:175], a[104:107], a[236:239], v[172:175]
v_mfma_f32_16x16x32_bf16 v[172:175], a[108:111], a[240:243], v[172:175]
s_mov_b32 s49, 1048576
s_waitcnt lgkmcnt(0)
v_pk_mul_f32 v[160:161], v[160:161], v[64:65]
v_pk_mul_f32 v[162:163], v[162:163], v[66:67]
v_pk_mul_f32 v[168:169], v[168:169], v[68:69]
v_pk_mul_f32 v[170:171], v[170:171], v[70:71]
v_pk_mul_f32 v[164:165], v[164:165], v[64:65]
v_pk_mul_f32 v[166:167], v[166:167], v[66:67]
v_pk_mul_f32 v[172:173], v[172:173], v[68:69]
v_pk_mul_f32 v[174:175], v[174:175], v[70:71]
s_xor_b32 s45, s60, s26
s_or_b32 s45, s45, s4
s_or_b32 s45, s45, s5
Lchk:
s_cmp_lg_u32 s45, 0
s_waitcnt vmcnt(0)
v_max3_u32 v248, v32, v33, v34
v_max3_u32 v249, v35, v36, v37
v_max3_u32 v248, v248, v38, v39
v_max_u32 v248, v248, v249
v_cmp_eq_u32 vcc, -1, v248
v_lshlrev_b32 v48, 16, v32
v_and_b32 v52, s31, v32
v_lshlrev_b32 v49, 16, v33
v_and_b32 v53, s31, v33
v_lshlrev_b32 v50, 16, v34
v_and_b32 v54, s31, v34
v_lshlrev_b32 v51, 16, v35
v_and_b32 v55, s31, v35
s_cbranch_vccnz Lpoll
Lgot:
s_cbranch_scc1 Lfartail
v_pk_fma_f32 v[48:49], v[48:49], v[64:65], v[160:161]
v_pk_fma_f32 v[52:53], v[52:53], v[64:65], v[164:165]
v_cvt_pk_bf16_f32 v16, v48, v52
v_cvt_pk_bf16_f32 v17, v49, v53
global_store_dword v12, v16, s[12:13] offset:0
global_store_dword v12, v17, s[12:13] offset:256
v_pk_fma_f32 v[50:51], v[50:51], v[66:67], v[162:163]
v_pk_fma_f32 v[54:55], v[54:55], v[66:67], v[166:167]
v_cvt_pk_bf16_f32 v18, v50, v54
v_cvt_pk_bf16_f32 v19, v51, v55
global_store_dword v12, v18, s[12:13] offset:512
global_store_dword v12, v19, s[12:13] offset:768
v_lshlrev_b32 v56, 16, v36
v_and_b32 v60, s31, v36
v_lshlrev_b32 v57, 16, v37
v_and_b32 v61, s31, v37
v_lshlrev_b32 v58, 16, v38
v_and_b32 v62, s31, v38
v_lshlrev_b32 v59, 16, v39
v_and_b32 v63, s31, v39
v_pk_fma_f32 v[56:57], v[56:57], v[68:69], v[168:169]
v_pk_fma_f32 v[60:61], v[60:61], v[68:69], v[172:173]
v_cvt_pk_bf16_f32 v20, v56, v60
v_cvt_pk_bf16_f32 v21, v57, v61
global_store_dword v13, v20, s[12:13] offset:0
global_store_dword v13, v21, s[12:13] offset:256
v_pk_fma_f32 v[58:59], v[58:59], v[70:71], v[170:171]
v_pk_fma_f32 v[62:63], v[62:63], v[70:71], v[174:175]
v_cvt_pk_bf16_f32 v22, v58, v62
v_cvt_pk_bf16_f32 v23, v59, v63
global_store_dword v13, v22, s[12:13] offset:512
global_store_dword v13, v23, s[12:13] offset:768
Lfin:
s_and_b32 s45, s57, 0x7ffff
s_cbranch_scc1 Lnoep
v_mov_b32 v1, 0
buffer_store_dword v251, v1, s[8:11], s44 offen
Lnoep:
Lend:
s_endpgm
Lpoll:
buffer_load_dwordx4 v[32:35], v14, s[12:15], s57 offen sc1
buffer_load_dwordx4 v[36:39], v15, s[12:15], s57 offen sc1
s_sub_u32 s49, s49, 1
s_cbranch_scc0 Lchk
s_branch Lfin
Lfartail:
s_cmp_lg_u64 s[4:5], 0
s_cbranch_scc1 Lsafe
v_pk_fma_f32 v[48:49], v[48:49], v[64:65], v[160:161]
v_pk_fma_f32 v[52:53], v[52:53], v[64:65], v[164:165]
v_cvt_pk_bf16_f32 v16, v48, v52
v_cvt_pk_bf16_f32 v17, v49, v53
global_store_dword v12, v16, s[12:13] offset:0 sc1
global_store_dword v12, v17, s[12:13] offset:256 sc1
v_pk_fma_f32 v[50:51], v[50:51], v[66:67], v[162:163]
v_pk_fma_f32 v[54:55], v[54:55], v[66:67], v[166:167]
v_cvt_pk_bf16_f32 v18, v50, v54
v_cvt_pk_bf16_f32 v19, v51, v55
global_store_dword v12, v18, s[12:13] offset:512 sc1
global_store_dword v12, v19, s[12:13] offset:768 sc1
v_lshlrev_b32 v56, 16, v36
v_and_b32 v60, s31, v36
v_lshlrev_b32 v57, 16, v37
v_and_b32 v61, s31, v37
v_lshlrev_b32 v58, 16, v38
v_and_b32 v62, s31, v38
v_lshlrev_b32 v59, 16, v39
v_and_b32 v63, s31, v39
v_pk_fma_f32 v[56:57], v[56:57], v[68:69], v[168:169]
v_pk_fma_f32 v[60:61], v[60:61], v[68:69], v[172:173]
v_cvt_pk_bf16_f32 v20, v56, v60
v_cvt_pk_bf16_f32 v21, v57, v61
global_store_dword v13, v20, s[12:13] offset:0 sc1
global_store_dword v13, v21, s[12:13] offset:256 sc1
v_pk_fma_f32 v[58:59], v[58:59], v[70:71], v[170:171]
v_pk_fma_f32 v[62:63], v[62:63], v[70:71], v[174:175]
v_cvt_pk_bf16_f32 v22, v58, v62
v_cvt_pk_bf16_f32 v23, v59, v63
global_store_dword v13, v22, s[12:13] offset:512 sc1
global_store_dword v13, v23, s[12:13] offset:768 sc1
s_branch Lfin
Lfarl:
buffer_store_dwordx2 v[250:251], v247, s[8:11], s33 offen sc1
s_branch Lfarlback
Lfarx:
buffer_store_dwordx4 v[16:19], v14, s[12:15], s61 offen sc1
s_branch Lfarxback
Lfary:
buffer_store_dwordx4 v[20:23], v15, s[12:15], s61 offen sc1
s_branch Lfaryback
Lrlslow:
s_mov_b32 s49, 1048576
Lrlspin:
buffer_load_dwordx2 v[248:249], v247, s[8:11], s52 offen sc1
s_sub_u32 s49, s49, 1
s_waitcnt vmcnt(0)
v_cmp_ne_u32 vcc, s24, v249
s_cbranch_scc1 Lrlback
s_cbranch_vccnz Lrlspin
s_branch Lrlback
Lkslow:
s_mov_b32 s49, 1048576
Lkspin:
buffer_load_dword v245, v249, s[8:11], s50 offen offset:0 sc1
s_sub_u32 s49, s49, 1
s_waitcnt vmcnt(0)
v_subrev_u32 v245, s24, v245
v_cmp_lt_u32 vcc, 7, v245
s_cbranch_scc1 Lkdone
s_cbranch_vccnz Lkspin
s_branch Lkdone
Lv0slow:
s_mov_b32 s49, 7
Lv0rep:
s_add_u32 s58, s58, 0x800
s_addc_u32 s59, s59, 0
s_load_dwordx4 s[0:3], s[58:59], 0
s_waitcnt lgkmcnt(0)
s_xor_b64 s[0:1], s[0:1], s[24:25]
s_xor_b64 s[2:3], s[2:3], s[24:25]
s_or_b64 s[0:1], s[0:1], s[2:3]
s_cbranch_scc0 Lv0back
s_sub_u32 s49, s49, 1
s_cmp_lg_u32 s49, 0
s_cbranch_scc1 Lv0rep
Lv0bslow:
s_mov_b32 s49, 1048576
Lv0bspin:
buffer_load_dword v245, v244, s[8:11], s6 offen offset:0 sc1
s_sub_u32 s49, s49, 1
s_waitcnt vmcnt(0)
v_subrev_u32 v245, s24, v245
v_cmp_lt_u32 vcc, 7, v245
s_cbranch_scc1 Lv0back
s_cbranch_vccnz Lv0bspin
s_branch Lv0back
Lvlslow:
v_add_u32 v246, s6, v244
s_add_u32 s49, s56, 8
v_mov_b32 v245, s49
v_cmp_lt_u32 vcc, 31, v0
s_nop 1
v_cndmask_b32 v246, v246, v245, vcc
s_mov_b32 s49, 1048576
Lvlspin:
buffer_load_dword v241, v246, s[8:11], 0 offen offset:0 sc1
s_sub_u32 s49, s49, 1
s_waitcnt vmcnt(0)
v_subrev_u32 v241, s24, v241
v_cmp_lt_u32 vcc, 7, v241
s_cbranch_scc1 Lvlback
s_cbranch_vccnz Lvlspin
s_branch Lvlback
Lrkslow:
s_mov_b32 s49, 1048576
Lrkspin:
buffer_load_dword v242, v249, s[8:11], s51 offen offset:0 sc1
s_sub_u32 s49, s49, 1
s_waitcnt vmcnt(0)
v_subrev_u32 v242, s24, v242
v_cmp_lt_u32 vcc, 7, v242
s_cbranch_scc1 Lrkback
s_cbranch_vccnz Lrkspin
s_branch Lrkback
Lrvslow:
s_mov_b32 s49, 1048576
Lrvspin:
buffer_load_dword v242, v244, s[8:11], s7 offen offset:0 sc1
s_sub_u32 s49, s49, 1
s_waitcnt vmcnt(0)
v_subrev_u32 v242, s24, v242
v_cmp_lt_u32 vcc, 7, v242
s_cbranch_scc1 Lrvback
s_cbranch_vccnz Lrvspin
s_branch Lrvback
Lsafe:
s_and_b32 s45, s32, 0xfff02000
s_add_u32 s46, s45, 0x100000
v_add_u32 v1, 4096, v11
v_mov_b32 v4, v11
v_and_b32 v2, 0x1fff, v2
v_add_u32 v2, 8192, v2
v_add_u32 v3, 1024, v2
v_mov_b32 v240, 0xff800000
v_mov_b32 v242, 0
v_mov_b32 v241, 0xff800000
v_mov_b32 v243, 0
v_mov_b32 v48, 0
v_mov_b32 v49, 0
v_mov_b32 v50, 0
v_mov_b32 v51, 0
v_mov_b32 v52, 0
v_mov_b32 v53, 0
v_mov_b32 v54, 0
v_mov_b32 v55, 0
v_mov_b32 v56, 0
v_mov_b32 v57, 0
v_mov_b32 v58, 0
v_mov_b32 v59, 0
v_mov_b32 v60, 0
v_mov_b32 v61, 0
v_mov_b32 v62, 0
v_mov_b32 v63, 0
Lsafe_loop:
buffer_load_dwordx4 a[116:119], v4, s[8:11], s45 offen offset:0 sc1
buffer_load_dwordx4 a[120:123], v4, s[8:11], s45 offen offset:1024 sc1
buffer_load_dwordx4 a[124:127], v4, s[8:11], s45 offen offset:2048 sc1
buffer_load_dwordx4 a[128:131], v4, s[8:11], s45 offen offset:3072 sc1
buffer_load_dwordx4 a[132:135], v1, s[8:11], s45 offen offset:0 sc1
buffer_load_dwordx4 a[136:139], v1, s[8:11], s45 offen offset:1024 sc1
buffer_load_dwordx4 a[140:143], v1, s[8:11], s45 offen offset:2048 sc1
buffer_load_dwordx4 a[144:147], v1, s[8:11], s45 offen offset:3072 sc1
buffer_load_dwordx4 a[148:151], v2, s[8:11], s45 offen sc1
buffer_load_dwordx4 a[152:155], v3, s[8:11], s45 offen sc1
s_add_u32 s45, s45, 16384
v_xor_b32 v1, 0x2000, v1
v_xor_b32 v2, 0x2000, v2
v_xor_b32 v3, 0x2000, v3
v_xor_b32 v4, 0x2000, v4
s_waitcnt vmcnt(0)
v_mfma_f32_16x16x32_bf16 v[80:83], a[116:119], a[32:35], 0
v_mfma_f32_16x16x32_bf16 v[80:83], a[120:123], a[36:39], v[80:83]
v_mfma_f32_16x16x32_bf16 v[80:83], a[124:127], a[40:43], v[80:83]
v_mfma_f32_16x16x32_bf16 v[80:83], a[128:131], a[44:47], v[80:83]
v_mfma_f32_16x16x32_bf16 v[84:87], a[132:135], a[32:35], 0
v_mfma_f32_16x16x32_bf16 v[84:87], a[136:139], a[36:39], v[84:87]
v_mfma_f32_16x16x32_bf16 v[84:87], a[140:143], a[40:43], v[84:87]
v_mfma_f32_16x16x32_bf16 v[84:87], a[144:147], a[44:47], v[84:87]
v_mfma_f32_16x16x32_bf16 v[88:91], a[116:119], a[48:51], 0
v_mfma_f32_16x16x32_bf16 v[88:91], a[120:123], a[52:55], v[88:91]
v_mfma_f32_16x16x32_bf16 v[88:91], a[124:127], a[56:59], v[88:91]
v_mfma_f32_16x16x32_bf16 v[88:91], a[128:131], a[60:63], v[88:91]
v_mfma_f32_16x16x32_bf16 v[92:95], a[132:135], a[48:51], 0
v_mfma_f32_16x16x32_bf16 v[92:95], a[136:139], a[52:55], v[92:95]
v_mfma_f32_16x16x32_bf16 v[92:95], a[140:143], a[56:59], v[92:95]
v_mfma_f32_16x16x32_bf16 v[92:95], a[144:147], a[60:63], v[92:95]
s_nop 15
v_max3_f32 v245, v80, v81, v240
v_max3_f32 v245, v82, v83, v245
v_max3_f32 v245, v84, v85, v245
v_max3_f32 v245, v86, v87, v245
v_mov_b32 v244, v245
s_nop 1
v_permlane32_swap_b32 v244, v245
v_max_f32 v245, v245, v244
v_mov_b32 v244, v245
s_nop 1
v_permlane16_swap_b32 v244, v245
v_max_f32 v245, v245, v244
v_sub_f32 v244, v240, v245
v_mov_b32 v240, v245
v_exp_f32 v244, v244
v_sub_f32 v80, v80, v245
v_sub_f32 v81, v81, v245
v_sub_f32 v82, v82, v245
v_sub_f32 v83, v83, v245
v_sub_f32 v84, v84, v245
v_sub_f32 v85, v85, v245
v_sub_f32 v86, v86, v245
v_sub_f32 v87, v87, v245
v_exp_f32 v80, v80
v_exp_f32 v81, v81
v_exp_f32 v82, v82
v_exp_f32 v83, v83
v_exp_f32 v84, v84
v_exp_f32 v85, v85
v_exp_f32 v86, v86
v_exp_f32 v87, v87
v_mul_f32 v242, v242, v244
v_mul_f32 v48, v48, v244
v_mul_f32 v49, v49, v244
v_mul_f32 v50, v50, v244
v_mul_f32 v51, v51, v244
v_mul_f32 v52, v52, v244
v_mul_f32 v53, v53, v244
v_mul_f32 v54, v54, v244
v_mul_f32 v55, v55, v244
v_add_f32 v242, v242, v80
v_add_f32 v242, v242, v81
v_add_f32 v242, v242, v82
v_add_f32 v242, v242, v83
v_add_f32 v242, v242, v84
v_add_f32 v242, v242, v85
v_add_f32 v242, v242, v86
v_add_f32 v242, v242, v87
v_cvt_pk_bf16_f32 v176, v80, v81
v_cvt_pk_bf16_f32 v177, v82, v83
v_cvt_pk_bf16_f32 v178, v84, v85
v_cvt_pk_bf16_f32 v179, v86, v87
v_max3_f32 v245, v88, v89, v241
v_max3_f32 v245, v90, v91, v245
v_max3_f32 v245, v92, v93, v245
v_max3_f32 v245, v94, v95, v245
v_mov_b32 v244, v245
s_nop 1
v_permlane32_swap_b32 v244, v245
v_max_f32 v245, v245, v244
v_mov_b32 v244, v245
s_nop 1
v_permlane16_swap_b32 v244, v245
v_max_f32 v245, v245, v244
v_sub_f32 v244, v241, v245
v_mov_b32 v241, v245
v_exp_f32 v244, v244
v_sub_f32 v88, v88, v245
v_sub_f32 v89, v89, v245
v_sub_f32 v90, v90, v245
v_sub_f32 v91, v91, v245
v_sub_f32 v92, v92, v245
v_sub_f32 v93, v93, v245
v_sub_f32 v94, v94, v245
v_sub_f32 v95, v95, v245
v_exp_f32 v88, v88
v_exp_f32 v89, v89
v_exp_f32 v90, v90
v_exp_f32 v91, v91
v_exp_f32 v92, v92
v_exp_f32 v93, v93
v_exp_f32 v94, v94
v_exp_f32 v95, v95
v_mul_f32 v243, v243, v244
v_mul_f32 v56, v56, v244
v_mul_f32 v57, v57, v244
v_mul_f32 v58, v58, v244
v_mul_f32 v59, v59, v244
v_mul_f32 v60, v60, v244
v_mul_f32 v61, v61, v244
v_mul_f32 v62, v62, v244
v_mul_f32 v63, v63, v244
v_add_f32 v243, v243, v88
v_add_f32 v243, v243, v89
v_add_f32 v243, v243, v90
v_add_f32 v243, v243, v91
v_add_f32 v243, v243, v92
v_add_f32 v243, v243, v93
v_add_f32 v243, v243, v94
v_add_f32 v243, v243, v95
v_cvt_pk_bf16_f32 v180, v88, v89
v_cvt_pk_bf16_f32 v181, v90, v91
v_cvt_pk_bf16_f32 v182, v92, v93
v_cvt_pk_bf16_f32 v183, v94, v95
s_nop 1
v_mfma_f32_16x16x32_bf16 v[48:51], a[148:151], v[176:179], v[48:51]
v_mfma_f32_16x16x32_bf16 v[52:55], a[152:155], v[176:179], v[52:55]
v_mfma_f32_16x16x32_bf16 v[56:59], a[148:151], v[180:183], v[56:59]
v_mfma_f32_16x16x32_bf16 v[60:63], a[152:155], v[180:183], v[60:63]
s_cmp_lt_u32 s45, s46
s_cbranch_scc1 Lsafe_loop
v_mov_b32 v244, v242
s_nop 1
v_permlane32_swap_b32 v244, v242
v_add_f32 v242, v242, v244
v_mov_b32 v244, v242
s_nop 1
v_permlane16_swap_b32 v244, v242
v_add_f32 v242, v242, v244
v_rcp_f32 v246, v242
v_mov_b32 v244, v243
s_nop 1
v_permlane32_swap_b32 v244, v243
v_add_f32 v243, v243, v244
v_mov_b32 v244, v243
s_nop 1
v_permlane16_swap_b32 v244, v243
v_add_f32 v243, v243, v244
v_rcp_f32 v247, v243
s_nop 15
v_pk_mul_f32 v[48:49], v[48:49], v[246:247] op_sel:[0,0] op_sel_hi:[1,0]
v_pk_mul_f32 v[50:51], v[50:51], v[246:247] op_sel:[0,0] op_sel_hi:[1,0]
v_pk_mul_f32 v[52:53], v[52:53], v[246:247] op_sel:[0,0] op_sel_hi:[1,0]
v_pk_mul_f32 v[54:55], v[54:55], v[246:247] op_sel:[0,0] op_sel_hi:[1,0]
v_pk_mul_f32 v[56:57], v[56:57], v[246:247] op_sel:[0,1] op_sel_hi:[1,1]
v_pk_mul_f32 v[58:59], v[58:59], v[246:247] op_sel:[0,1] op_sel_hi:[1,1]
v_pk_mul_f32 v[60:61], v[60:61], v[246:247] op_sel:[0,1] op_sel_hi:[1,1]
v_pk_mul_f32 v[62:63], v[62:63], v[246:247] op_sel:[0,1] op_sel_hi:[1,1]
v_cvt_pk_bf16_f32 v16, v48, v52
v_cvt_pk_bf16_f32 v17, v49, v53
v_cvt_pk_bf16_f32 v18, v50, v54
v_cvt_pk_bf16_f32 v19, v51, v55
v_cvt_pk_bf16_f32 v20, v56, v60
v_cvt_pk_bf16_f32 v21, v57, v61
v_cvt_pk_bf16_f32 v22, v58, v62
v_cvt_pk_bf16_f32 v23, v59, v63
v_and_b32 v12, 15, v0
v_and_b32 v13, 48, v0
v_lshl_add_u32 v12, v12, 8, v13
v_add_u32 v13, 4096, v12
s_cmp_eq_u32 s60, s26
s_cbranch_scc0 Lsafe_far
buffer_store_dwordx4 v[16:19], v12, s[12:15], s57 offen
buffer_store_dwordx4 v[20:23], v13, s[12:15], s57 offen
s_branch Lfin
Lsafe_far:
buffer_store_dwordx4 v[16:19], v12, s[12:15], s57 offen sc1
buffer_store_dwordx4 v[20:23], v13, s[12:15], s57 offen sc1
s_branch Lfin
Lcode_end:

.section .rodata,"a"
.p2align 6
.amdhsa_kernel standalone__kv_cache_quant_pre_rope_vs_post_rope__prompt_kernel
  .amdhsa_next_free_vgpr 500
  .amdhsa_next_free_sgpr 64
  .amdhsa_accum_offset 256
  .amdhsa_group_segment_fixed_size 0
  .amdhsa_kernarg_size 112
  .amdhsa_user_sgpr_count 2
  .amdhsa_user_sgpr_kernarg_segment_ptr 1
  .amdhsa_system_sgpr_workgroup_id_x 1
.end_amdhsa_kernel
.text
```
